```python
import torch

def _softmax(x, axis=-1):
    return torch.softmax(x, dim=axis)
def _gelu(x):
    return torch.nn.functional.gelu(x, approximate="tanh")
def _silu(x):
    return torch.nn.functional.silu(x)
def _sigmoid(x):
    return torch.sigmoid(x)
def _layernorm(x, axis=-1, eps=1e-5):
    m = x.mean(dim=axis, keepdim=True)
    v = x.var(dim=axis, keepdim=True, unbiased=False)
    return (x - m) / torch.sqrt(v + eps)
def _scatter_add(tgt, idx, src, axis=0):
    return tgt.clone().index_add_(axis, idx, src)
def _segment_sum(src, seg, n):
    out = torch.zeros((n,) + src.shape[1:], dtype=src.dtype)
    return out.index_add_(0, seg, src)
def _pad(x, pw):
    flat = tuple(v for pair in reversed(pw) for v in pair)
    return torch.nn.functional.pad(x, flat)

kernel_name = 'parallel_sum__gqa_block_cached__geglu_ffn__decode'

def setup_inputs():

    _w = (lambda a: (lambda t: t.to(torch.bfloat16) if t.is_floating_point() else t)(torch.as_tensor(a)))
    def _A_setup():
        B, Sq, D = 1, 1, 512
        Hq, Hkv, Sk, Dh = 32, 32, 4096, 128
        assert Hq % Hkv == 0, (Hq, Hkv)
        return {
            "x": _w((lambda *s: torch.randn(*s, dtype=torch.bfloat16) * 0.05)(B, Sq, D)),
            "k_cache": _w((lambda *s: torch.randn(*s, dtype=torch.bfloat16) * 3.2)(B, Hkv, Sk, Dh)),
            "v_cache": _w((lambda *s: torch.randn(*s, dtype=torch.bfloat16) * 1.6)(B, Hkv, Sk, Dh)),
            "wq": _w((lambda *s: torch.randn(*s, dtype=torch.bfloat16) * 3.2)(D, Hq * Dh) * (D ** -0.5)),
            "wo": _w((lambda *s: torch.randn(*s, dtype=torch.bfloat16) * 1.6)(Hq * Dh, D) * ((Hq * Dh) ** -0.5)),
        }
    _A_in = _A_setup()

    def _B_setup():
        B, S, D, F = 1, 1, 512, 1376
        return {
            "x": _w((lambda *s: torch.randn(*s, dtype=torch.bfloat16) * 0.05)(B, S, D)),
            "w_gate": _w((lambda *s: torch.randn(*s, dtype=torch.bfloat16) * 0.05)(D, F)),
            "w_up": _w((lambda *s: torch.randn(*s, dtype=torch.bfloat16) * 0.05)(D, F)),
            "w_down": _w((lambda *s: torch.randn(*s, dtype=torch.bfloat16) * 0.05)(F, D)),
        }
    _B_in = _B_setup()

    return {
        "A_x": _A_in["x"],
        "A_k_cache": _A_in["k_cache"],
        "A_v_cache": _A_in["v_cache"],
        "A_wq": _A_in["wq"],
        "A_wo": _A_in["wo"],
        "B_x": _B_in["x"],
        "B_w_gate": _B_in["w_gate"],
        "B_w_up": _B_in["w_up"],
        "B_w_down": _B_in["w_down"],
    }

def reference(A_x, A_k_cache, A_v_cache, A_wq, A_wo, B_x, B_w_gate, B_w_up, B_w_down):
    def _A_ref(x, k_cache, v_cache, wq, wo):
        B, Sq, D = x.shape
        Hq, Dh = 32, 128
        Hkv = k_cache.shape[1]
        rep = Hq // Hkv
        q = (lambda x, *d: x.permute(*d))((x @ wq).reshape(B, Sq, Hq, Dh), 0, 2, 1, 3)
        k = (lambda x, n, axis: torch.repeat_interleave(x, n, dim=axis))(k_cache, rep, axis=1)
        v = (lambda x, n, axis: torch.repeat_interleave(x, n, dim=axis))(v_cache, rep, axis=1)
        scores = torch.einsum("bhqd,bhkd->bhqk", q, k) * (Dh ** -0.5)
        p = _softmax(scores, axis=-1)
        o = torch.einsum("bhqk,bhkd->bhqd", p, v)
        return (lambda x, *d: x.permute(*d))(o, 0, 2, 1, 3).reshape(B, Sq, Hq * Dh) @ wo

    def _B_ref(x, w_gate, w_up, w_down):
        return (_gelu(x @ w_gate) * (x @ w_up)) @ w_down

    x = A_x
    xn = _layernorm(x, axis=-1)
    return x + _A_ref(xn, A_k_cache, A_v_cache, A_wq, A_wo) + _B_ref(xn, B_w_gate, B_w_up, B_w_down)
```

```asm
; @launch grid=(256,1,1) block=(640,1,1) lds=98304
.amdgcn_target "amdgcn-amd-amdhsa--gfx950"
.text
.globl parallel_sum__gqa_block_cached__geglu_ffn__decode_kernel
.p2align 8
.type parallel_sum__gqa_block_cached__geglu_ffn__decode_kernel,@function
parallel_sum__gqa_block_cached__geglu_ffn__decode_kernel:
s_cmp_ge_u32 s2, 0x100
s_cbranch_scc1 L_end
s_load_dwordx16 s[4:19], s[0:1], 0
s_load_dwordx8 s[20:27], s[0:1], 64
s_getpc_b64 s[48:49]
v_lshlrev_b32 v4, 4, v0
s_and_b32 s48, s48, 0xffffff00
v_min_u32 v4, (L_last-parallel_sum__gqa_block_cached__geglu_ffn__decode_kernel-16)&0xfffffff0, v4
v_mov_b32 v5, 0
v_lshl_add_u64 v[4:5], v[4:5], 0, s[48:49]
global_load_dwordx4 v[60:63], v[4:5], off
v_lshrrev_b32 v1, 6, v0
v_and_b32 v0, 63, v0
s_and_b32 s28, s2, 7
s_lshl_b32 s28, s28, 2
v_readfirstlane_b32 s3, v1
s_bfe_u32 s29, s2, 0x20003
s_add_u32 s28, s28, s29
s_lshr_b32 s29, s2, 5
s_lshl_b32 s30, s28, 3
s_add_u32 s30, s30, s29
s_and_b32 s48, s2, 7
s_mul_i32 s52, s48, 43
s_add_u32 s53, s52, 43
s_lshr_b32 s52, s52, 3
s_lshr_b32 s53, s53, 3
s_sub_u32 s53, s53, s52
s_and_b32 s48, s28, 3
s_mul_i32 s48, s48, s53
s_lshl_b32 s52, s52, 2
s_add_u32 s52, s52, s48
v_and_b32 v2, 15, v0
v_lshrrev_b32 v3, 4, v0
s_cmp_lt_u32 s3, 2
s_cbranch_scc1 L_ctrl
s_sub_u32 s34, s3, 2
s_and_b32 s34, s34, 3
s_lshl_b32 s48, s30, 17
s_lshl_b32 s49, s34, 12
s_add_u32 s48, s48, s49
v_lshl_add_u32 v1, v0, 4, s48
s_mov_b32 s38, 0x2000000
s_mov_b32 s39, 0x20000
s_cmp_ge_u32 s3, 6
s_cbranch_scc1 L_val
s_setprio 2
s_waitcnt lgkmcnt(0)
s_mov_b32 s36, s6
s_mov_b32 s37, s7
s_mov_b32 s48, 0
buffer_load_dwordx4 v[32:35], v1, s[36:39], s48 offen offset:0 nt
buffer_load_dwordx4 v[36:39], v1, s[36:39], s48 offen offset:1024 nt
buffer_load_dwordx4 v[40:43], v1, s[36:39], s48 offen offset:2048 nt
buffer_load_dwordx4 v[44:47], v1, s[36:39], s48 offen offset:3072 nt
s_barrier
s_mov_b32 s48, 16384
buffer_load_dwordx4 v[48:51], v1, s[36:39], s48 offen offset:0 nt
buffer_load_dwordx4 v[52:55], v1, s[36:39], s48 offen offset:1024 nt
s_waitcnt vmcnt(5)
buffer_load_dwordx4 v[56:59], v1, s[36:39], s48 offen offset:2048 nt
s_waitcnt vmcnt(5)
buffer_load_dwordx4 v[60:63], v1, s[36:39], s48 offen offset:3072 nt
s_waitcnt vmcnt(5)
s_mov_b32 s48, 32768
buffer_load_dwordx4 v[64:67], v1, s[36:39], s48 offen offset:0 nt
s_waitcnt vmcnt(5)
buffer_load_dwordx4 v[68:71], v1, s[36:39], s48 offen offset:1024 nt
s_waitcnt vmcnt(5)
buffer_load_dwordx4 v[72:75], v1, s[36:39], s48 offen offset:2048 nt
s_waitcnt vmcnt(5)
buffer_load_dwordx4 v[76:79], v1, s[36:39], s48 offen offset:3072 nt
s_waitcnt vmcnt(5)
s_mov_b32 s48, 49152
buffer_load_dwordx4 v[80:83], v1, s[36:39], s48 offen offset:0 nt
s_waitcnt vmcnt(5)
buffer_load_dwordx4 v[84:87], v1, s[36:39], s48 offen offset:1024 nt
s_waitcnt vmcnt(5)
buffer_load_dwordx4 v[88:91], v1, s[36:39], s48 offen offset:2048 nt
s_waitcnt vmcnt(5)
buffer_load_dwordx4 v[92:95], v1, s[36:39], s48 offen offset:3072 nt
s_waitcnt vmcnt(5)
s_mov_b32 s48, 65536
buffer_load_dwordx4 v[96:99], v1, s[36:39], s48 offen offset:0 nt
s_waitcnt vmcnt(5)
buffer_load_dwordx4 v[100:103], v1, s[36:39], s48 offen offset:1024 nt
s_waitcnt vmcnt(5)
buffer_load_dwordx4 v[104:107], v1, s[36:39], s48 offen offset:2048 nt
s_waitcnt vmcnt(5)
buffer_load_dwordx4 v[108:111], v1, s[36:39], s48 offen offset:3072 nt
s_waitcnt vmcnt(5)
s_mov_b32 s48, 81920
buffer_load_dwordx4 v[112:115], v1, s[36:39], s48 offen offset:0 nt
s_waitcnt vmcnt(5)
buffer_load_dwordx4 v[116:119], v1, s[36:39], s48 offen offset:1024 nt
s_waitcnt vmcnt(5)
buffer_load_dwordx4 v[120:123], v1, s[36:39], s48 offen offset:2048 nt
s_waitcnt vmcnt(5)
buffer_load_dwordx4 v[124:127], v1, s[36:39], s48 offen offset:3072 nt
s_waitcnt vmcnt(5)
s_mov_b32 s48, 98304
buffer_load_dwordx4 v[128:131], v1, s[36:39], s48 offen offset:0 nt
s_waitcnt vmcnt(5)
buffer_load_dwordx4 v[132:135], v1, s[36:39], s48 offen offset:1024 nt
s_waitcnt vmcnt(5)
buffer_load_dwordx4 v[136:139], v1, s[36:39], s48 offen offset:2048 nt
s_waitcnt vmcnt(5)
buffer_load_dwordx4 v[140:143], v1, s[36:39], s48 offen offset:3072 nt
s_waitcnt vmcnt(5)
s_mov_b32 s48, 114688
buffer_load_dwordx4 v[144:147], v1, s[36:39], s48 offen offset:0 nt
s_waitcnt vmcnt(5)
buffer_load_dwordx4 v[148:151], v1, s[36:39], s48 offen offset:1024 nt
s_waitcnt vmcnt(5)
buffer_load_dwordx4 v[152:155], v1, s[36:39], s48 offen offset:2048 nt
v_mov_b32 v20, 768
v_mov_b32 v4, 1
s_mov_b64 exec, 1
ds_add_u32 v20, v4 offset:20
s_mov_b64 exec, -1
s_waitcnt vmcnt(5)
buffer_load_dwordx4 v[156:159], v1, s[36:39], s48 offen offset:3072 nt
v_and_b32 v4, 2, v0
v_cmp_ne_u32 s[50:51], 0, v4
v_and_b32 v4, 1, v0
v_cmp_ne_u32 s[54:55], 0, v4
v_mov_b32 v20, 768
v_lshlrev_b32 v21, 4, v2
v_mov_b32 v31, 1069066811
s_mov_b32 s32, 0
L_wait_q:
ds_read_b32 v7, v20 offset:0
s_add_u32 s32, s32, 1
s_waitcnt lgkmcnt(0)
v_readfirstlane_b32 s48, v7
s_cmp_ge_u32 s48, 1
s_cbranch_scc1 L_go_q
s_sleep 2
s_cmp_lt_u32 s32, 1048576
s_cbranch_scc1 L_wait_q
L_go_q:
ds_read_b128 v[4:7], v21 offset:0
ds_read_b32 v22, v20 offset:4
s_waitcnt vmcnt(16) lgkmcnt(0)
v_readfirstlane_b32 s31, v22
v_dot2_f32_bf16 v32, v32, v4, 0
v_dot2_f32_bf16 v36, v36, v4, 0
v_dot2_f32_bf16 v40, v40, v4, 0
v_dot2_f32_bf16 v44, v44, v4, 0
v_dot2_f32_bf16 v48, v48, v4, 0
v_dot2_f32_bf16 v52, v52, v4, 0
v_dot2_f32_bf16 v56, v56, v4, 0
v_dot2_f32_bf16 v60, v60, v4, 0
v_dot2_f32_bf16 v64, v64, v4, 0
v_dot2_f32_bf16 v68, v68, v4, 0
v_dot2_f32_bf16 v72, v72, v4, 0
v_dot2_f32_bf16 v76, v76, v4, 0
v_dot2_f32_bf16 v80, v80, v4, 0
v_dot2_f32_bf16 v84, v84, v4, 0
v_dot2_f32_bf16 v88, v88, v4, 0
v_dot2_f32_bf16 v92, v92, v4, 0
v_dot2_f32_bf16 v32, v33, v5, v32
v_dot2_f32_bf16 v36, v37, v5, v36
v_dot2_f32_bf16 v40, v41, v5, v40
v_dot2_f32_bf16 v44, v45, v5, v44
v_dot2_f32_bf16 v48, v49, v5, v48
v_dot2_f32_bf16 v52, v53, v5, v52
v_dot2_f32_bf16 v56, v57, v5, v56
v_dot2_f32_bf16 v60, v61, v5, v60
v_dot2_f32_bf16 v64, v65, v5, v64
v_dot2_f32_bf16 v68, v69, v5, v68
v_dot2_f32_bf16 v72, v73, v5, v72
v_dot2_f32_bf16 v76, v77, v5, v76
v_dot2_f32_bf16 v80, v81, v5, v80
v_dot2_f32_bf16 v84, v85, v5, v84
v_dot2_f32_bf16 v88, v89, v5, v88
v_dot2_f32_bf16 v92, v93, v5, v92
v_dot2_f32_bf16 v32, v34, v6, v32
v_dot2_f32_bf16 v36, v38, v6, v36
v_dot2_f32_bf16 v40, v42, v6, v40
v_dot2_f32_bf16 v44, v46, v6, v44
v_dot2_f32_bf16 v48, v50, v6, v48
v_dot2_f32_bf16 v52, v54, v6, v52
v_dot2_f32_bf16 v56, v58, v6, v56
v_dot2_f32_bf16 v60, v62, v6, v60
v_dot2_f32_bf16 v64, v66, v6, v64
v_dot2_f32_bf16 v68, v70, v6, v68
v_dot2_f32_bf16 v72, v74, v6, v72
v_dot2_f32_bf16 v76, v78, v6, v76
v_dot2_f32_bf16 v80, v82, v6, v80
v_dot2_f32_bf16 v84, v86, v6, v84
v_dot2_f32_bf16 v88, v90, v6, v88
v_dot2_f32_bf16 v92, v94, v6, v92
v_dot2_f32_bf16 v32, v35, v7, v32
v_dot2_f32_bf16 v36, v39, v7, v36
v_dot2_f32_bf16 v40, v43, v7, v40
v_dot2_f32_bf16 v44, v47, v7, v44
v_dot2_f32_bf16 v48, v51, v7, v48
v_dot2_f32_bf16 v52, v55, v7, v52
v_dot2_f32_bf16 v56, v59, v7, v56
v_dot2_f32_bf16 v60, v63, v7, v60
v_dot2_f32_bf16 v64, v67, v7, v64
v_dot2_f32_bf16 v68, v71, v7, v68
v_dot2_f32_bf16 v72, v75, v7, v72
v_dot2_f32_bf16 v76, v79, v7, v76
v_dot2_f32_bf16 v80, v83, v7, v80
v_dot2_f32_bf16 v84, v87, v7, v84
v_dot2_f32_bf16 v88, v91, v7, v88
v_dot2_f32_bf16 v92, v95, v7, v92
v_add_f32_dpp v32, v32, v32 row_ror:8 row_mask:0xf bank_mask:0x3
v_add_f32_dpp v36, v36, v36 row_ror:8 row_mask:0xf bank_mask:0x3
v_add_f32_dpp v40, v40, v40 row_ror:8 row_mask:0xf bank_mask:0x3
v_add_f32_dpp v44, v44, v44 row_ror:8 row_mask:0xf bank_mask:0x3
v_add_f32_dpp v48, v48, v48 row_ror:8 row_mask:0xf bank_mask:0x3
v_add_f32_dpp v52, v52, v52 row_ror:8 row_mask:0xf bank_mask:0x3
v_add_f32_dpp v56, v56, v56 row_ror:8 row_mask:0xf bank_mask:0x3
v_add_f32_dpp v60, v60, v60 row_ror:8 row_mask:0xf bank_mask:0x3
v_add_f32_dpp v32, v64, v64 row_ror:8 row_mask:0xf bank_mask:0xc
v_add_f32_dpp v36, v68, v68 row_ror:8 row_mask:0xf bank_mask:0xc
v_add_f32_dpp v40, v72, v72 row_ror:8 row_mask:0xf bank_mask:0xc
v_add_f32_dpp v44, v76, v76 row_ror:8 row_mask:0xf bank_mask:0xc
v_add_f32_dpp v48, v80, v80 row_ror:8 row_mask:0xf bank_mask:0xc
v_add_f32_dpp v52, v84, v84 row_ror:8 row_mask:0xf bank_mask:0xc
v_add_f32_dpp v56, v88, v88 row_ror:8 row_mask:0xf bank_mask:0xc
v_add_f32_dpp v60, v92, v92 row_ror:8 row_mask:0xf bank_mask:0xc
v_add_f32_dpp v32, v32, v32 row_shl:4 row_mask:0xf bank_mask:0x5
v_add_f32_dpp v36, v36, v36 row_shl:4 row_mask:0xf bank_mask:0x5
v_add_f32_dpp v40, v40, v40 row_shl:4 row_mask:0xf bank_mask:0x5
v_add_f32_dpp v44, v44, v44 row_shl:4 row_mask:0xf bank_mask:0x5
v_add_f32_dpp v32, v48, v48 row_shr:4 row_mask:0xf bank_mask:0xa
v_add_f32_dpp v36, v52, v52 row_shr:4 row_mask:0xf bank_mask:0xa
v_add_f32_dpp v40, v56, v56 row_shr:4 row_mask:0xf bank_mask:0xa
v_add_f32_dpp v44, v60, v60 row_shr:4 row_mask:0xf bank_mask:0xa
v_cndmask_b32 v8, v32, v40, s[50:51]
v_cndmask_b32 v10, v40, v32, s[50:51]
v_cndmask_b32 v9, v36, v44, s[50:51]
v_cndmask_b32 v11, v44, v36, s[50:51]
s_nop 0
v_add_f32_dpp v8, v10, v8 quad_perm:[2,3,0,1] row_mask:0xf bank_mask:0xf
v_add_f32_dpp v9, v11, v9 quad_perm:[2,3,0,1] row_mask:0xf bank_mask:0xf
v_cndmask_b32 v11, v9, v8, s[54:55]
v_cndmask_b32 v10, v8, v9, s[54:55]
s_nop 0
v_add_f32_dpp v16, v11, v10 quad_perm:[1,0,3,2] row_mask:0xf bank_mask:0xf
s_waitcnt vmcnt(8)
v_dot2_f32_bf16 v96, v96, v4, 0
v_dot2_f32_bf16 v100, v100, v4, 0
v_dot2_f32_bf16 v104, v104, v4, 0
v_dot2_f32_bf16 v108, v108, v4, 0
v_dot2_f32_bf16 v112, v112, v4, 0
v_dot2_f32_bf16 v116, v116, v4, 0
v_dot2_f32_bf16 v120, v120, v4, 0
v_dot2_f32_bf16 v124, v124, v4, 0
v_dot2_f32_bf16 v96, v97, v5, v96
v_dot2_f32_bf16 v100, v101, v5, v100
v_dot2_f32_bf16 v104, v105, v5, v104
v_dot2_f32_bf16 v108, v109, v5, v108
v_dot2_f32_bf16 v112, v113, v5, v112
v_dot2_f32_bf16 v116, v117, v5, v116
v_dot2_f32_bf16 v120, v121, v5, v120
v_dot2_f32_bf16 v124, v125, v5, v124
v_dot2_f32_bf16 v96, v98, v6, v96
v_dot2_f32_bf16 v100, v102, v6, v100
v_dot2_f32_bf16 v104, v106, v6, v104
v_dot2_f32_bf16 v108, v110, v6, v108
v_dot2_f32_bf16 v112, v114, v6, v112
v_dot2_f32_bf16 v116, v118, v6, v116
v_dot2_f32_bf16 v120, v122, v6, v120
v_dot2_f32_bf16 v124, v126, v6, v124
v_dot2_f32_bf16 v96, v99, v7, v96
v_dot2_f32_bf16 v100, v103, v7, v100
v_dot2_f32_bf16 v104, v107, v7, v104
v_dot2_f32_bf16 v108, v111, v7, v108
v_dot2_f32_bf16 v112, v115, v7, v112
v_dot2_f32_bf16 v116, v119, v7, v116
v_dot2_f32_bf16 v120, v123, v7, v120
v_dot2_f32_bf16 v124, v127, v7, v124
s_waitcnt vmcnt(0)
v_dot2_f32_bf16 v128, v128, v4, 0
v_dot2_f32_bf16 v132, v132, v4, 0
v_dot2_f32_bf16 v136, v136, v4, 0
v_dot2_f32_bf16 v140, v140, v4, 0
v_dot2_f32_bf16 v144, v144, v4, 0
v_dot2_f32_bf16 v148, v148, v4, 0
v_dot2_f32_bf16 v152, v152, v4, 0
v_dot2_f32_bf16 v156, v156, v4, 0
v_dot2_f32_bf16 v128, v129, v5, v128
v_dot2_f32_bf16 v132, v133, v5, v132
v_dot2_f32_bf16 v136, v137, v5, v136
v_dot2_f32_bf16 v140, v141, v5, v140
v_dot2_f32_bf16 v144, v145, v5, v144
v_dot2_f32_bf16 v148, v149, v5, v148
v_dot2_f32_bf16 v152, v153, v5, v152
v_dot2_f32_bf16 v156, v157, v5, v156
v_dot2_f32_bf16 v128, v130, v6, v128
v_dot2_f32_bf16 v132, v134, v6, v132
v_dot2_f32_bf16 v136, v138, v6, v136
v_dot2_f32_bf16 v140, v142, v6, v140
v_dot2_f32_bf16 v144, v146, v6, v144
v_dot2_f32_bf16 v148, v150, v6, v148
v_dot2_f32_bf16 v152, v154, v6, v152
v_dot2_f32_bf16 v156, v158, v6, v156
v_dot2_f32_bf16 v128, v131, v7, v128
v_dot2_f32_bf16 v132, v135, v7, v132
v_dot2_f32_bf16 v136, v139, v7, v136
v_dot2_f32_bf16 v140, v143, v7, v140
v_dot2_f32_bf16 v144, v147, v7, v144
v_dot2_f32_bf16 v148, v151, v7, v148
v_dot2_f32_bf16 v152, v155, v7, v152
v_dot2_f32_bf16 v156, v159, v7, v156
v_add_f32_dpp v96, v96, v96 row_ror:8 row_mask:0xf bank_mask:0x3
v_add_f32_dpp v100, v100, v100 row_ror:8 row_mask:0xf bank_mask:0x3
v_add_f32_dpp v104, v104, v104 row_ror:8 row_mask:0xf bank_mask:0x3
v_add_f32_dpp v108, v108, v108 row_ror:8 row_mask:0xf bank_mask:0x3
v_add_f32_dpp v112, v112, v112 row_ror:8 row_mask:0xf bank_mask:0x3
v_add_f32_dpp v116, v116, v116 row_ror:8 row_mask:0xf bank_mask:0x3
v_add_f32_dpp v120, v120, v120 row_ror:8 row_mask:0xf bank_mask:0x3
v_add_f32_dpp v124, v124, v124 row_ror:8 row_mask:0xf bank_mask:0x3
v_add_f32_dpp v96, v128, v128 row_ror:8 row_mask:0xf bank_mask:0xc
v_add_f32_dpp v100, v132, v132 row_ror:8 row_mask:0xf bank_mask:0xc
v_add_f32_dpp v104, v136, v136 row_ror:8 row_mask:0xf bank_mask:0xc
v_add_f32_dpp v108, v140, v140 row_ror:8 row_mask:0xf bank_mask:0xc
v_add_f32_dpp v112, v144, v144 row_ror:8 row_mask:0xf bank_mask:0xc
v_add_f32_dpp v116, v148, v148 row_ror:8 row_mask:0xf bank_mask:0xc
v_add_f32_dpp v120, v152, v152 row_ror:8 row_mask:0xf bank_mask:0xc
v_add_f32_dpp v124, v156, v156 row_ror:8 row_mask:0xf bank_mask:0xc
v_add_f32_dpp v96, v96, v96 row_shl:4 row_mask:0xf bank_mask:0x5
v_add_f32_dpp v100, v100, v100 row_shl:4 row_mask:0xf bank_mask:0x5
v_add_f32_dpp v104, v104, v104 row_shl:4 row_mask:0xf bank_mask:0x5
v_add_f32_dpp v108, v108, v108 row_shl:4 row_mask:0xf bank_mask:0x5
v_add_f32_dpp v96, v112, v112 row_shr:4 row_mask:0xf bank_mask:0xa
v_add_f32_dpp v100, v116, v116 row_shr:4 row_mask:0xf bank_mask:0xa
v_add_f32_dpp v104, v120, v120 row_shr:4 row_mask:0xf bank_mask:0xa
v_add_f32_dpp v108, v124, v124 row_shr:4 row_mask:0xf bank_mask:0xa
v_cndmask_b32 v8, v96, v104, s[50:51]
v_cndmask_b32 v10, v104, v96, s[50:51]
v_cndmask_b32 v9, v100, v108, s[50:51]
v_cndmask_b32 v11, v108, v100, s[50:51]
s_nop 0
v_add_f32_dpp v8, v10, v8 quad_perm:[2,3,0,1] row_mask:0xf bank_mask:0xf
v_add_f32_dpp v9, v11, v9 quad_perm:[2,3,0,1] row_mask:0xf bank_mask:0xf
v_cndmask_b32 v11, v9, v8, s[54:55]
v_cndmask_b32 v10, v8, v9, s[54:55]
s_nop 0
v_add_f32_dpp v17, v11, v10 quad_perm:[1,0,3,2] row_mask:0xf bank_mask:0xf
v_cvt_pk_bf16_f32 v18, v16, v17
v_lshlrev_b32 v16, 16, v18
v_and_b32 v17, 0xffff0000, v18
v_mul_f32 v16, 1035273459, v16
v_mul_f32 v17, 1035273459, v17
v_cvt_pk_bf16_f32 v18, v16, v17
v_lshlrev_b32 v16, 16, v18
v_and_b32 v17, 0xffff0000, v18
v_max_f32 v18, v16, v17
s_nop 1
v_max_f32_dpp v18, v18, v18 row_ror:8 row_mask:0xf bank_mask:0xf
s_nop 1
v_max_f32_dpp v18, v18, v18 row_ror:4 row_mask:0xf bank_mask:0xf
s_nop 1
v_max_f32_dpp v18, v18, v18 row_ror:2 row_mask:0xf bank_mask:0xf
s_nop 1
v_max_f32_dpp v18, v18, v18 row_ror:1 row_mask:0xf bank_mask:0xf
s_nop 1
v_max_f32_dpp v18, v18, v18 row_bcast:15 row_mask:0xa bank_mask:0xf
s_nop 1
v_max_f32_dpp v18, v18, v18 row_bcast:31 row_mask:0xc bank_mask:0xf
s_nop 0
v_readlane_b32 s49, v18, 63
s_lshl_b32 s48, s34, 9
s_add_u32 s48, s48, 3072
v_lshl_add_u32 v19, v0, 2, s48
ds_write2st64_b32 v19, v16, v17 offset0:0 offset1:1
v_subrev_f32 v8, s49, v16
v_subrev_f32 v9, s49, v17
v_mul_f32 v8, v8, v31
v_mul_f32 v9, v9, v31
v_exp_f32 v8, v8
v_exp_f32 v9, v9
s_nop 0
v_add_f32 v18, v8, v9
s_nop 1
v_add_f32_dpp v18, v18, v18 row_ror:8 row_mask:0xf bank_mask:0xf
s_nop 1
v_add_f32_dpp v18, v18, v18 row_ror:4 row_mask:0xf bank_mask:0xf
s_nop 1
v_add_f32_dpp v18, v18, v18 row_ror:2 row_mask:0xf bank_mask:0xf
s_nop 1
v_add_f32_dpp v18, v18, v18 row_ror:1 row_mask:0xf bank_mask:0xf
s_nop 1
v_add_f32_dpp v18, v18, v18 row_bcast:15 row_mask:0xa bank_mask:0xf
s_nop 1
v_add_f32_dpp v18, v18, v18 row_bcast:31 row_mask:0xc bank_mask:0xf
s_lshl_b32 s48, s34, 3
v_mov_b32 v16, s48
v_mov_b32 v19, s49
v_mov_b32 v17, 1
s_mov_b32 exec_lo, 0
s_mov_b32 exec_hi, 0x80000000
ds_write2_b32 v16, v19, v18 offset0:208 offset1:209
ds_add_u32 v20, v17 offset:12
s_mov_b64 exec, -1
s_setprio 0
s_mov_b32 s32, 0
L_wait_v:
ds_read_b32 v7, v20 offset:16
s_add_u32 s32, s32, 1
s_waitcnt lgkmcnt(0)
v_readfirstlane_b32 s48, v7
s_cmp_ge_u32 s48, 4
s_cbranch_scc1 L_go_v
s_sleep 1
s_cmp_lt_u32 s32, 1048576
s_cbranch_scc1 L_wait_v
L_go_v:
s_mov_b32 s56, s12
s_mov_b32 s57, s13
s_mov_b32 s58, 0x400000
s_mov_b32 s59, 0x20000
s_mov_b32 s44, s20
s_mov_b32 s45, s21
s_mov_b32 s46, 1409024
s_mov_b32 s47, 0x20000
v_lshrrev_b32 v24, 3, v0
v_and_b32 v25, 1, v3
v_lshlrev_b32 v25, 1, v25
v_and_b32 v26, 7, v0
v_xor_b32 v25, v25, v26
v_lshlrev_b32 v25, 4, v25
v_lshl_add_u32 v25, v24, 10, v25
v_xor_b32 v26, 64, v25
s_lshl_b32 s49, s29, 7
s_lshl_b32 s50, s28, 17
s_add_u32 s50, s50, s49
s_lshl_b32 s48, s34, 15
s_add_u32 s50, s50, s48
s_lshl_b32 s51, s34, 1
s_add_u32 s48, s52, s51
s_lshl_b32 s48, s48, 13
s_add_u32 s48, s48, s49
s_add_u32 s49, s48, 0x2000
s_cmp_lt_u32 s51, s53
s_cselect_b32 s54, 0, 0x40000000
v_or_b32 v27, s54, v25
s_add_u32 s51, s51, 1
s_cmp_lt_u32 s51, s53
s_cselect_b32 s54, 0, 0x40000000
v_or_b32 v28, s54, v26
s_lshl_b32 s51, s34, 11
s_add_u32 m0, s51, 24576
s_lshl_b32 s54, s34, 12
buffer_load_dwordx4 v27, s[44:47], s48 offen nt lds
s_add_u32 m0, s51, 25600
s_nop 0
buffer_load_dwordx4 v28, s[44:47], s49 offen nt lds
s_add_u32 m0, s54, 8192
s_add_u32 s49, s50, 0
buffer_load_dwordx4 v25, s[56:59], s49 offen nt lds
s_add_u32 m0, s54, 9216
s_add_u32 s49, s50, 8192
buffer_load_dwordx4 v26, s[56:59], s49 offen nt lds
s_add_u32 m0, s54, 10240
s_add_u32 s49, s50, 16384
buffer_load_dwordx4 v25, s[56:59], s49 offen nt lds
s_add_u32 m0, s54, 11264
s_add_u32 s49, s50, 24576
buffer_load_dwordx4 v26, s[56:59], s49 offen nt lds
v_bfe_u32 v24, v2, 3, 1
v_and_b32 v25, 1, v3
v_lshl_add_u32 v24, v25, 1, v24
v_xor_b32 v24, s34, v24
v_lshlrev_b32 v24, 5, v24
v_lshl_add_u32 v24, v3, 10, v24
v_lshrrev_b32 v25, 2, v2
v_lshl_add_u32 v24, v25, 7, v24
v_and_b32 v25, 3, v2
v_lshl_add_u32 v24, v25, 3, v24
v_lshlrev_b32 v27, 4, v3
v_mov_b32 v26, 1
s_lshl_b32 s48, s29, 16
s_and_b32 s49, s28, 7
s_lshl_b32 s49, s49, 10
s_add_u32 s48, s48, s49
s_lshr_b32 s49, s28, 3
s_lshl_b32 s49, s49, 13
s_add_u32 s48, s48, s49
s_lshr_b32 s49, s29, 2
s_xor_b32 s49, s49, 0
s_lshl_b32 s49, s49, 13
s_lshl_b32 s49, s34, 8
s_add_u32 s48, s48, s49
s_add_u32 s48, s48, 1048576
v_lshl_add_u32 v29, v0, 4, s48
s_waitcnt lgkmcnt(0)
s_barrier
ds_read_b128 v[48:51], v27 offset:256
ds_read_b128 v[52:55], v27 offset:320
s_mov_b64 exec, 1
s_waitcnt vmcnt(0)
ds_add_u32 v20, v26 offset:8
s_mov_b64 exec, -1
s_mov_b32 s32, 0
L_wait_w:
ds_read_b32 v26, v20 offset:8
s_add_u32 s32, s32, 1
s_waitcnt lgkmcnt(0)
v_readfirstlane_b32 s48, v26
s_cmp_ge_u32 s48, 4
s_cbranch_scc1 L_go_w
s_cmp_lt_u32 s32, 1048576
s_cbranch_scc1 L_wait_w
L_go_w:
ds_read_b64_tr_b16 v[112:113], v24 offset:24576
ds_read_b64_tr_b16 v[114:115], v24 offset:25088
ds_read_b64_tr_b16 v[116:117], v24 offset:28672
ds_read_b64_tr_b16 v[118:119], v24 offset:29184
ds_read_b64_tr_b16 v[96:97], v24 offset:8192
ds_read_b64_tr_b16 v[98:99], v24 offset:8704
ds_read_b64_tr_b16 v[100:101], v24 offset:12288
ds_read_b64_tr_b16 v[102:103], v24 offset:12800
ds_read_b64_tr_b16 v[104:105], v24 offset:16384
ds_read_b64_tr_b16 v[106:107], v24 offset:16896
ds_read_b64_tr_b16 v[108:109], v24 offset:20480
ds_read_b64_tr_b16 v[110:111], v24 offset:20992
s_waitcnt lgkmcnt(8)
v_mfma_f32_16x16x32_bf16 v[20:23], v[48:51], v[112:115], 0
v_mfma_f32_16x16x32_bf16 v[20:23], v[52:55], v[116:119], v[20:23]
v_mov_b32 v5, s31
v_mov_b32 v7, s31
s_nop 5
v_mov_b32 v6, v20
s_waitcnt lgkmcnt(0)
s_barrier
ds_read_b128 v[32:35], v27 offset:512
ds_read_b128 v[36:39], v27 offset:576
ds_read_b128 v[40:43], v27 offset:640
ds_read_b128 v[44:47], v27 offset:704
s_waitcnt lgkmcnt(3)
v_mfma_f32_16x16x32_bf16 v[16:19], v[32:35], v[96:99], 0
s_waitcnt lgkmcnt(2)
v_mfma_f32_16x16x32_bf16 v[16:19], v[36:39], v[100:103], v[16:19]
s_waitcnt lgkmcnt(1)
v_mfma_f32_16x16x32_bf16 v[16:19], v[40:43], v[104:107], v[16:19]
s_waitcnt lgkmcnt(0)
v_mfma_f32_16x16x32_bf16 v[16:19], v[44:47], v[108:111], v[16:19]
s_nop 6
s_mov_b64 exec, 0xffff
v_mov_b32 v4, v16
global_store_dwordx4 v29, v[4:7], s[26:27] sc1
s_endpgm
L_val:
s_setprio 1
v_and_b32 v4, 2, v2
v_cmp_eq_u32 vcc, 0, v4
v_mov_b32 v5, 0xffff0000
v_mov_b32 v6, 0xffff
v_cndmask_b32 v5, v5, v6, vcc
v_and_b32 v4, 13, v2
v_cmp_eq_u32 vcc, 0, v4
s_nop 1
v_cndmask_b32 v8, 0, v5, vcc
v_cmp_eq_u32 vcc, 4, v4
s_nop 1
v_cndmask_b32 v9, 0, v5, vcc
v_cmp_eq_u32 vcc, 8, v4
s_nop 1
v_cndmask_b32 v10, 0, v5, vcc
v_cmp_eq_u32 vcc, 12, v4
s_nop 1
v_cndmask_b32 v11, 0, v5, vcc
v_mov_b32 v20, 768
s_lshl_b32 s48, s34, 9
s_add_u32 s49, s48, 3072
v_lshl_add_u32 v19, v0, 2, s49
s_add_u32 s49, s48, 1024
v_lshl_add_u32 v18, v0, 3, s49
v_mov_b32 v23, 1069066811
v_mov_b32 v6, 1
s_waitcnt lgkmcnt(0)
s_mov_b32 s36, s8
s_mov_b32 s37, s9
s_barrier
s_mov_b32 s32, 0
L_wait_k:
ds_read_b32 v7, v20 offset:20
s_add_u32 s32, s32, 1
s_waitcnt lgkmcnt(0)
v_readfirstlane_b32 s48, v7
s_cmp_ge_u32 s48, 4
s_cbranch_scc1 L_go_k
s_sleep 1
s_cmp_lt_u32 s32, 1048576
s_cbranch_scc1 L_wait_k
L_go_k:
s_mov_b32 s48, 0
buffer_load_dwordx4 v[32:35], v1, s[36:39], s48 offen offset:0 nt
buffer_load_dwordx4 v[36:39], v1, s[36:39], s48 offen offset:1024 nt
buffer_load_dwordx4 v[40:43], v1, s[36:39], s48 offen offset:2048 nt
buffer_load_dwordx4 v[44:47], v1, s[36:39], s48 offen offset:3072 nt
s_mov_b32 s48, 16384
buffer_load_dwordx4 v[48:51], v1, s[36:39], s48 offen offset:0 nt
buffer_load_dwordx4 v[52:55], v1, s[36:39], s48 offen offset:1024 nt
buffer_load_dwordx4 v[56:59], v1, s[36:39], s48 offen offset:2048 nt
buffer_load_dwordx4 v[60:63], v1, s[36:39], s48 offen offset:3072 nt
s_waitcnt vmcnt(7)
s_mov_b32 s48, 32768
buffer_load_dwordx4 v[64:67], v1, s[36:39], s48 offen offset:0 nt
s_waitcnt vmcnt(7)
buffer_load_dwordx4 v[68:71], v1, s[36:39], s48 offen offset:1024 nt
s_waitcnt vmcnt(7)
buffer_load_dwordx4 v[72:75], v1, s[36:39], s48 offen offset:2048 nt
s_waitcnt vmcnt(7)
buffer_load_dwordx4 v[76:79], v1, s[36:39], s48 offen offset:3072 nt
s_waitcnt vmcnt(7)
s_mov_b32 s48, 49152
buffer_load_dwordx4 v[80:83], v1, s[36:39], s48 offen offset:0 nt
s_waitcnt vmcnt(7)
buffer_load_dwordx4 v[84:87], v1, s[36:39], s48 offen offset:1024 nt
s_waitcnt vmcnt(7)
buffer_load_dwordx4 v[88:91], v1, s[36:39], s48 offen offset:2048 nt
s_waitcnt vmcnt(7)
buffer_load_dwordx4 v[92:95], v1, s[36:39], s48 offen offset:3072 nt
s_waitcnt vmcnt(7)
s_mov_b32 s48, 65536
buffer_load_dwordx4 v[96:99], v1, s[36:39], s48 offen offset:0 nt
s_waitcnt vmcnt(7)
buffer_load_dwordx4 v[100:103], v1, s[36:39], s48 offen offset:1024 nt
s_waitcnt vmcnt(7)
buffer_load_dwordx4 v[104:107], v1, s[36:39], s48 offen offset:2048 nt
s_waitcnt vmcnt(7)
buffer_load_dwordx4 v[108:111], v1, s[36:39], s48 offen offset:3072 nt
s_waitcnt vmcnt(7)
s_mov_b32 s48, 81920
buffer_load_dwordx4 v[112:115], v1, s[36:39], s48 offen offset:0 nt
s_waitcnt vmcnt(7)
buffer_load_dwordx4 v[116:119], v1, s[36:39], s48 offen offset:1024 nt
s_waitcnt vmcnt(7)
buffer_load_dwordx4 v[120:123], v1, s[36:39], s48 offen offset:2048 nt
s_waitcnt vmcnt(7)
buffer_load_dwordx4 v[124:127], v1, s[36:39], s48 offen offset:3072 nt
s_waitcnt vmcnt(7)
s_mov_b32 s48, 98304
buffer_load_dwordx4 v[128:131], v1, s[36:39], s48 offen offset:0 nt
s_waitcnt vmcnt(7)
buffer_load_dwordx4 v[132:135], v1, s[36:39], s48 offen offset:1024 nt
s_waitcnt vmcnt(7)
buffer_load_dwordx4 v[136:139], v1, s[36:39], s48 offen offset:2048 nt
s_waitcnt vmcnt(7)
buffer_load_dwordx4 v[140:143], v1, s[36:39], s48 offen offset:3072 nt
s_waitcnt vmcnt(7)
s_mov_b32 s48, 114688
buffer_load_dwordx4 v[144:147], v1, s[36:39], s48 offen offset:0 nt
s_waitcnt vmcnt(7)
buffer_load_dwordx4 v[148:151], v1, s[36:39], s48 offen offset:1024 nt
s_waitcnt vmcnt(7)
buffer_load_dwordx4 v[152:155], v1, s[36:39], s48 offen offset:2048 nt
s_waitcnt vmcnt(7)
buffer_load_dwordx4 v[156:159], v1, s[36:39], s48 offen offset:3072 nt
s_mov_b64 exec, 1
ds_add_u32 v20, v6 offset:16
s_mov_b64 exec, -1
s_mov_b32 s32, 0
L_wait_p:
ds_read_b32 v7, v20 offset:24
s_add_u32 s32, s32, 1
s_waitcnt lgkmcnt(0)
v_readfirstlane_b32 s48, v7
s_cmp_ge_u32 s48, 1
s_cbranch_scc1 L_go_p
s_sleep 1
s_cmp_lt_u32 s32, 1048576
s_cbranch_scc1 L_wait_p
L_go_p:
ds_read2st64_b32 v[16:17], v19 offset0:0 offset1:1
ds_read_b64 v[4:5], v20 offset:32
s_waitcnt lgkmcnt(0)
v_sub_f32 v16, v16, v4
v_sub_f32 v17, v17, v4
v_mul_f32 v16, v16, v23
v_mul_f32 v17, v17, v23
v_exp_f32 v16, v16
v_exp_f32 v17, v17
s_nop 0
v_mul_f32 v16, v16, v5
v_mul_f32 v17, v17, v5
v_cvt_pk_bf16_f32 v16, v16, v16
v_cvt_pk_bf16_f32 v17, v17, v17
s_nop 0
v_and_b32_dpp v24, v16, v8 row_newbcast:0 row_mask:0xf bank_mask:0xf
v_and_b32_dpp v25, v16, v9 row_newbcast:0 row_mask:0xf bank_mask:0xf
v_and_b32_dpp v26, v16, v10 row_newbcast:0 row_mask:0xf bank_mask:0xf
v_and_b32_dpp v27, v16, v11 row_newbcast:0 row_mask:0xf bank_mask:0xf
v_and_b32_dpp v28, v16, v8 row_newbcast:1 row_mask:0xf bank_mask:0xf
v_and_b32_dpp v29, v16, v9 row_newbcast:1 row_mask:0xf bank_mask:0xf
v_and_b32_dpp v30, v16, v10 row_newbcast:1 row_mask:0xf bank_mask:0xf
v_and_b32_dpp v31, v16, v11 row_newbcast:1 row_mask:0xf bank_mask:0xf
s_waitcnt vmcnt(31)
v_mfma_f32_16x16x32_bf16 v[12:15], v[24:27], v[32:35], 0
v_and_b32_dpp v24, v16, v8 row_newbcast:2 row_mask:0xf bank_mask:0xf
v_and_b32_dpp v25, v16, v9 row_newbcast:2 row_mask:0xf bank_mask:0xf
v_and_b32_dpp v26, v16, v10 row_newbcast:2 row_mask:0xf bank_mask:0xf
v_and_b32_dpp v27, v16, v11 row_newbcast:2 row_mask:0xf bank_mask:0xf
s_waitcnt vmcnt(30)
v_mfma_f32_16x16x32_bf16 v[12:15], v[28:31], v[36:39], v[12:15]
v_and_b32_dpp v28, v16, v8 row_newbcast:3 row_mask:0xf bank_mask:0xf
v_and_b32_dpp v29, v16, v9 row_newbcast:3 row_mask:0xf bank_mask:0xf
v_and_b32_dpp v30, v16, v10 row_newbcast:3 row_mask:0xf bank_mask:0xf
v_and_b32_dpp v31, v16, v11 row_newbcast:3 row_mask:0xf bank_mask:0xf
s_waitcnt vmcnt(29)
v_mfma_f32_16x16x32_bf16 v[12:15], v[24:27], v[40:43], v[12:15]
v_and_b32_dpp v24, v16, v8 row_newbcast:4 row_mask:0xf bank_mask:0xf
v_and_b32_dpp v25, v16, v9 row_newbcast:4 row_mask:0xf bank_mask:0xf
v_and_b32_dpp v26, v16, v10 row_newbcast:4 row_mask:0xf bank_mask:0xf
v_and_b32_dpp v27, v16, v11 row_newbcast:4 row_mask:0xf bank_mask:0xf
s_waitcnt vmcnt(28)
v_mfma_f32_16x16x32_bf16 v[12:15], v[28:31], v[44:47], v[12:15]
v_and_b32_dpp v28, v16, v8 row_newbcast:5 row_mask:0xf bank_mask:0xf
v_and_b32_dpp v29, v16, v9 row_newbcast:5 row_mask:0xf bank_mask:0xf
v_and_b32_dpp v30, v16, v10 row_newbcast:5 row_mask:0xf bank_mask:0xf
v_and_b32_dpp v31, v16, v11 row_newbcast:5 row_mask:0xf bank_mask:0xf
s_waitcnt vmcnt(27)
v_mfma_f32_16x16x32_bf16 v[12:15], v[24:27], v[48:51], v[12:15]
v_and_b32_dpp v24, v16, v8 row_newbcast:6 row_mask:0xf bank_mask:0xf
v_and_b32_dpp v25, v16, v9 row_newbcast:6 row_mask:0xf bank_mask:0xf
v_and_b32_dpp v26, v16, v10 row_newbcast:6 row_mask:0xf bank_mask:0xf
v_and_b32_dpp v27, v16, v11 row_newbcast:6 row_mask:0xf bank_mask:0xf
s_waitcnt vmcnt(26)
v_mfma_f32_16x16x32_bf16 v[12:15], v[28:31], v[52:55], v[12:15]
v_and_b32_dpp v28, v16, v8 row_newbcast:7 row_mask:0xf bank_mask:0xf
v_and_b32_dpp v29, v16, v9 row_newbcast:7 row_mask:0xf bank_mask:0xf
v_and_b32_dpp v30, v16, v10 row_newbcast:7 row_mask:0xf bank_mask:0xf
v_and_b32_dpp v31, v16, v11 row_newbcast:7 row_mask:0xf bank_mask:0xf
s_waitcnt vmcnt(25)
v_mfma_f32_16x16x32_bf16 v[12:15], v[24:27], v[56:59], v[12:15]
v_and_b32_dpp v24, v16, v8 row_newbcast:8 row_mask:0xf bank_mask:0xf
v_and_b32_dpp v25, v16, v9 row_newbcast:8 row_mask:0xf bank_mask:0xf
v_and_b32_dpp v26, v16, v10 row_newbcast:8 row_mask:0xf bank_mask:0xf
v_and_b32_dpp v27, v16, v11 row_newbcast:8 row_mask:0xf bank_mask:0xf
s_waitcnt vmcnt(24)
v_mfma_f32_16x16x32_bf16 v[12:15], v[28:31], v[60:63], v[12:15]
v_and_b32_dpp v28, v16, v8 row_newbcast:9 row_mask:0xf bank_mask:0xf
v_and_b32_dpp v29, v16, v9 row_newbcast:9 row_mask:0xf bank_mask:0xf
v_and_b32_dpp v30, v16, v10 row_newbcast:9 row_mask:0xf bank_mask:0xf
v_and_b32_dpp v31, v16, v11 row_newbcast:9 row_mask:0xf bank_mask:0xf
s_waitcnt vmcnt(23)
v_mfma_f32_16x16x32_bf16 v[12:15], v[24:27], v[64:67], v[12:15]
v_and_b32_dpp v24, v16, v8 row_newbcast:10 row_mask:0xf bank_mask:0xf
v_and_b32_dpp v25, v16, v9 row_newbcast:10 row_mask:0xf bank_mask:0xf
v_and_b32_dpp v26, v16, v10 row_newbcast:10 row_mask:0xf bank_mask:0xf
v_and_b32_dpp v27, v16, v11 row_newbcast:10 row_mask:0xf bank_mask:0xf
s_waitcnt vmcnt(22)
v_mfma_f32_16x16x32_bf16 v[12:15], v[28:31], v[68:71], v[12:15]
v_and_b32_dpp v28, v16, v8 row_newbcast:11 row_mask:0xf bank_mask:0xf
v_and_b32_dpp v29, v16, v9 row_newbcast:11 row_mask:0xf bank_mask:0xf
v_and_b32_dpp v30, v16, v10 row_newbcast:11 row_mask:0xf bank_mask:0xf
v_and_b32_dpp v31, v16, v11 row_newbcast:11 row_mask:0xf bank_mask:0xf
s_waitcnt vmcnt(21)
v_mfma_f32_16x16x32_bf16 v[12:15], v[24:27], v[72:75], v[12:15]
v_and_b32_dpp v24, v16, v8 row_newbcast:12 row_mask:0xf bank_mask:0xf
v_and_b32_dpp v25, v16, v9 row_newbcast:12 row_mask:0xf bank_mask:0xf
v_and_b32_dpp v26, v16, v10 row_newbcast:12 row_mask:0xf bank_mask:0xf
v_and_b32_dpp v27, v16, v11 row_newbcast:12 row_mask:0xf bank_mask:0xf
s_waitcnt vmcnt(20)
v_mfma_f32_16x16x32_bf16 v[12:15], v[28:31], v[76:79], v[12:15]
v_and_b32_dpp v28, v16, v8 row_newbcast:13 row_mask:0xf bank_mask:0xf
v_and_b32_dpp v29, v16, v9 row_newbcast:13 row_mask:0xf bank_mask:0xf
v_and_b32_dpp v30, v16, v10 row_newbcast:13 row_mask:0xf bank_mask:0xf
v_and_b32_dpp v31, v16, v11 row_newbcast:13 row_mask:0xf bank_mask:0xf
s_waitcnt vmcnt(19)
v_mfma_f32_16x16x32_bf16 v[12:15], v[24:27], v[80:83], v[12:15]
v_and_b32_dpp v24, v16, v8 row_newbcast:14 row_mask:0xf bank_mask:0xf
v_and_b32_dpp v25, v16, v9 row_newbcast:14 row_mask:0xf bank_mask:0xf
v_and_b32_dpp v26, v16, v10 row_newbcast:14 row_mask:0xf bank_mask:0xf
v_and_b32_dpp v27, v16, v11 row_newbcast:14 row_mask:0xf bank_mask:0xf
s_waitcnt vmcnt(18)
v_mfma_f32_16x16x32_bf16 v[12:15], v[28:31], v[84:87], v[12:15]
v_and_b32_dpp v28, v16, v8 row_newbcast:15 row_mask:0xf bank_mask:0xf
v_and_b32_dpp v29, v16, v9 row_newbcast:15 row_mask:0xf bank_mask:0xf
v_and_b32_dpp v30, v16, v10 row_newbcast:15 row_mask:0xf bank_mask:0xf
v_and_b32_dpp v31, v16, v11 row_newbcast:15 row_mask:0xf bank_mask:0xf
s_waitcnt vmcnt(17)
v_mfma_f32_16x16x32_bf16 v[12:15], v[24:27], v[88:91], v[12:15]
v_and_b32_dpp v24, v17, v8 row_newbcast:0 row_mask:0xf bank_mask:0xf
v_and_b32_dpp v25, v17, v9 row_newbcast:0 row_mask:0xf bank_mask:0xf
v_and_b32_dpp v26, v17, v10 row_newbcast:0 row_mask:0xf bank_mask:0xf
v_and_b32_dpp v27, v17, v11 row_newbcast:0 row_mask:0xf bank_mask:0xf
s_waitcnt vmcnt(16)
v_mfma_f32_16x16x32_bf16 v[12:15], v[28:31], v[92:95], v[12:15]
v_and_b32_dpp v28, v17, v8 row_newbcast:1 row_mask:0xf bank_mask:0xf
v_and_b32_dpp v29, v17, v9 row_newbcast:1 row_mask:0xf bank_mask:0xf
v_and_b32_dpp v30, v17, v10 row_newbcast:1 row_mask:0xf bank_mask:0xf
v_and_b32_dpp v31, v17, v11 row_newbcast:1 row_mask:0xf bank_mask:0xf
s_waitcnt vmcnt(15)
v_mfma_f32_16x16x32_bf16 v[12:15], v[24:27], v[96:99], v[12:15]
v_and_b32_dpp v24, v17, v8 row_newbcast:2 row_mask:0xf bank_mask:0xf
v_and_b32_dpp v25, v17, v9 row_newbcast:2 row_mask:0xf bank_mask:0xf
v_and_b32_dpp v26, v17, v10 row_newbcast:2 row_mask:0xf bank_mask:0xf
v_and_b32_dpp v27, v17, v11 row_newbcast:2 row_mask:0xf bank_mask:0xf
s_waitcnt vmcnt(14)
v_mfma_f32_16x16x32_bf16 v[12:15], v[28:31], v[100:103], v[12:15]
v_and_b32_dpp v28, v17, v8 row_newbcast:3 row_mask:0xf bank_mask:0xf
v_and_b32_dpp v29, v17, v9 row_newbcast:3 row_mask:0xf bank_mask:0xf
v_and_b32_dpp v30, v17, v10 row_newbcast:3 row_mask:0xf bank_mask:0xf
v_and_b32_dpp v31, v17, v11 row_newbcast:3 row_mask:0xf bank_mask:0xf
s_waitcnt vmcnt(13)
v_mfma_f32_16x16x32_bf16 v[12:15], v[24:27], v[104:107], v[12:15]
v_and_b32_dpp v24, v17, v8 row_newbcast:4 row_mask:0xf bank_mask:0xf
v_and_b32_dpp v25, v17, v9 row_newbcast:4 row_mask:0xf bank_mask:0xf
v_and_b32_dpp v26, v17, v10 row_newbcast:4 row_mask:0xf bank_mask:0xf
v_and_b32_dpp v27, v17, v11 row_newbcast:4 row_mask:0xf bank_mask:0xf
s_waitcnt vmcnt(12)
v_mfma_f32_16x16x32_bf16 v[12:15], v[28:31], v[108:111], v[12:15]
v_and_b32_dpp v28, v17, v8 row_newbcast:5 row_mask:0xf bank_mask:0xf
v_and_b32_dpp v29, v17, v9 row_newbcast:5 row_mask:0xf bank_mask:0xf
v_and_b32_dpp v30, v17, v10 row_newbcast:5 row_mask:0xf bank_mask:0xf
v_and_b32_dpp v31, v17, v11 row_newbcast:5 row_mask:0xf bank_mask:0xf
s_waitcnt vmcnt(11)
v_mfma_f32_16x16x32_bf16 v[12:15], v[24:27], v[112:115], v[12:15]
v_and_b32_dpp v24, v17, v8 row_newbcast:6 row_mask:0xf bank_mask:0xf
v_and_b32_dpp v25, v17, v9 row_newbcast:6 row_mask:0xf bank_mask:0xf
v_and_b32_dpp v26, v17, v10 row_newbcast:6 row_mask:0xf bank_mask:0xf
v_and_b32_dpp v27, v17, v11 row_newbcast:6 row_mask:0xf bank_mask:0xf
s_waitcnt vmcnt(10)
v_mfma_f32_16x16x32_bf16 v[12:15], v[28:31], v[116:119], v[12:15]
v_and_b32_dpp v28, v17, v8 row_newbcast:7 row_mask:0xf bank_mask:0xf
v_and_b32_dpp v29, v17, v9 row_newbcast:7 row_mask:0xf bank_mask:0xf
v_and_b32_dpp v30, v17, v10 row_newbcast:7 row_mask:0xf bank_mask:0xf
v_and_b32_dpp v31, v17, v11 row_newbcast:7 row_mask:0xf bank_mask:0xf
s_waitcnt vmcnt(9)
v_mfma_f32_16x16x32_bf16 v[12:15], v[24:27], v[120:123], v[12:15]
v_and_b32_dpp v24, v17, v8 row_newbcast:8 row_mask:0xf bank_mask:0xf
v_and_b32_dpp v25, v17, v9 row_newbcast:8 row_mask:0xf bank_mask:0xf
v_and_b32_dpp v26, v17, v10 row_newbcast:8 row_mask:0xf bank_mask:0xf
v_and_b32_dpp v27, v17, v11 row_newbcast:8 row_mask:0xf bank_mask:0xf
s_waitcnt vmcnt(8)
v_mfma_f32_16x16x32_bf16 v[12:15], v[28:31], v[124:127], v[12:15]
v_and_b32_dpp v28, v17, v8 row_newbcast:9 row_mask:0xf bank_mask:0xf
v_and_b32_dpp v29, v17, v9 row_newbcast:9 row_mask:0xf bank_mask:0xf
v_and_b32_dpp v30, v17, v10 row_newbcast:9 row_mask:0xf bank_mask:0xf
v_and_b32_dpp v31, v17, v11 row_newbcast:9 row_mask:0xf bank_mask:0xf
s_waitcnt vmcnt(7)
v_mfma_f32_16x16x32_bf16 v[12:15], v[24:27], v[128:131], v[12:15]
v_and_b32_dpp v24, v17, v8 row_newbcast:10 row_mask:0xf bank_mask:0xf
v_and_b32_dpp v25, v17, v9 row_newbcast:10 row_mask:0xf bank_mask:0xf
v_and_b32_dpp v26, v17, v10 row_newbcast:10 row_mask:0xf bank_mask:0xf
v_and_b32_dpp v27, v17, v11 row_newbcast:10 row_mask:0xf bank_mask:0xf
s_waitcnt vmcnt(6)
v_mfma_f32_16x16x32_bf16 v[12:15], v[28:31], v[132:135], v[12:15]
v_and_b32_dpp v28, v17, v8 row_newbcast:11 row_mask:0xf bank_mask:0xf
v_and_b32_dpp v29, v17, v9 row_newbcast:11 row_mask:0xf bank_mask:0xf
v_and_b32_dpp v30, v17, v10 row_newbcast:11 row_mask:0xf bank_mask:0xf
v_and_b32_dpp v31, v17, v11 row_newbcast:11 row_mask:0xf bank_mask:0xf
s_waitcnt vmcnt(5)
v_mfma_f32_16x16x32_bf16 v[12:15], v[24:27], v[136:139], v[12:15]
v_and_b32_dpp v24, v17, v8 row_newbcast:12 row_mask:0xf bank_mask:0xf
v_and_b32_dpp v25, v17, v9 row_newbcast:12 row_mask:0xf bank_mask:0xf
v_and_b32_dpp v26, v17, v10 row_newbcast:12 row_mask:0xf bank_mask:0xf
v_and_b32_dpp v27, v17, v11 row_newbcast:12 row_mask:0xf bank_mask:0xf
s_waitcnt vmcnt(4)
v_mfma_f32_16x16x32_bf16 v[12:15], v[28:31], v[140:143], v[12:15]
v_and_b32_dpp v28, v17, v8 row_newbcast:13 row_mask:0xf bank_mask:0xf
v_and_b32_dpp v29, v17, v9 row_newbcast:13 row_mask:0xf bank_mask:0xf
v_and_b32_dpp v30, v17, v10 row_newbcast:13 row_mask:0xf bank_mask:0xf
v_and_b32_dpp v31, v17, v11 row_newbcast:13 row_mask:0xf bank_mask:0xf
s_waitcnt vmcnt(3)
v_mfma_f32_16x16x32_bf16 v[12:15], v[24:27], v[144:147], v[12:15]
v_and_b32_dpp v24, v17, v8 row_newbcast:14 row_mask:0xf bank_mask:0xf
v_and_b32_dpp v25, v17, v9 row_newbcast:14 row_mask:0xf bank_mask:0xf
v_and_b32_dpp v26, v17, v10 row_newbcast:14 row_mask:0xf bank_mask:0xf
v_and_b32_dpp v27, v17, v11 row_newbcast:14 row_mask:0xf bank_mask:0xf
s_waitcnt vmcnt(2)
v_mfma_f32_16x16x32_bf16 v[12:15], v[28:31], v[148:151], v[12:15]
v_and_b32_dpp v28, v17, v8 row_newbcast:15 row_mask:0xf bank_mask:0xf
v_and_b32_dpp v29, v17, v9 row_newbcast:15 row_mask:0xf bank_mask:0xf
v_and_b32_dpp v30, v17, v10 row_newbcast:15 row_mask:0xf bank_mask:0xf
v_and_b32_dpp v31, v17, v11 row_newbcast:15 row_mask:0xf bank_mask:0xf
s_waitcnt vmcnt(1)
v_mfma_f32_16x16x32_bf16 v[12:15], v[24:27], v[152:155], v[12:15]
s_nop 0
s_waitcnt vmcnt(0)
v_mfma_f32_16x16x32_bf16 v[12:15], v[28:31], v[156:159], v[12:15]
s_nop 7
ds_write2_b32 v18, v12, v14 offset0:0 offset1:1
s_waitcnt lgkmcnt(0)
s_barrier
s_endpgm
L_ctrl:
s_setprio 3
s_movk_i32 s48, 2752
s_sub_u32 s50, s53, 1
s_cmp_eq_u32 s3, 0
s_cselect_b32 s48, 0x2000, s48
s_cselect_b32 s50, 7, s50
s_lshr_b32 s51, s29, 1
s_lshl_b32 s51, s51, 7
v_lshl_add_u32 v4, v3, 5, s51
v_lshrrev_b32 v5, 3, v2
v_lshl_add_u32 v6, v5, 4, v4
v_and_b32 v5, 7, v2
v_min_u32 v5, s50, v5
v_mul_lo_u32 v6, v6, s48
v_lshl_add_u32 v22, v5, 4, v6
v_and_b32 v5, 1, v2
v_lshl_add_u32 v4, v5, 4, v4
v_lshlrev_b32 v4, 1, v4
v_lshlrev_b32 v5, 4, v0
v_mov_b32 v7, 0
v_mov_b32 v20, 768
s_lshl_b32 s54, s28, 1
s_and_b32 s51, s29, 1
s_add_u32 s54, s54, s51
s_lshl_b32 s54, s54, 7
s_lshl_b32 s55, s52, 4
ds_write2_b32 v20, v7, v7 offset0:2 offset1:3
ds_write2_b32 v20, v7, v7 offset0:0 offset1:4
ds_write2_b32 v20, v7, v7 offset0:5 offset1:6
s_waitcnt lgkmcnt(0)
global_load_dword v21, v7, s[26:27] sc1
global_load_dwordx4 v[16:19], v5, s[4:5]
global_load_dwordx4 v[8:11], v4, s[4:5]
global_load_dwordx4 v[12:15], v4, s[4:5] offset:16
s_cmp_eq_u32 s51, 0
s_cselect_b64 s[56:57], s[16:17], s[18:19]
s_cmp_eq_u32 s3, 0
s_cselect_b64 s[56:57], s[10:11], s[56:57]
s_cselect_b32 s54, s54, s55
s_add_u32 s56, s56, s54
s_addc_u32 s57, s57, 0
global_load_dwordx4 v[64:67], v22, s[56:57] nt
s_add_u32 s56, s56, s48
s_addc_u32 s57, s57, 0
global_load_dwordx4 v[68:71], v22, s[56:57] nt
s_add_u32 s56, s56, s48
s_addc_u32 s57, s57, 0
global_load_dwordx4 v[72:75], v22, s[56:57] nt
s_add_u32 s56, s56, s48
s_addc_u32 s57, s57, 0
global_load_dwordx4 v[76:79], v22, s[56:57] nt
s_add_u32 s56, s56, s48
s_addc_u32 s57, s57, 0
global_load_dwordx4 v[80:83], v22, s[56:57] nt
s_add_u32 s56, s56, s48
s_addc_u32 s57, s57, 0
global_load_dwordx4 v[84:87], v22, s[56:57] nt
s_add_u32 s56, s56, s48
s_addc_u32 s57, s57, 0
global_load_dwordx4 v[88:91], v22, s[56:57] nt
s_add_u32 s56, s56, s48
s_addc_u32 s57, s57, 0
global_load_dwordx4 v[92:95], v22, s[56:57] nt
s_add_u32 s56, s56, s48
s_addc_u32 s57, s57, 0
global_load_dwordx4 v[96:99], v22, s[56:57] nt
s_add_u32 s56, s56, s48
s_addc_u32 s57, s57, 0
global_load_dwordx4 v[100:103], v22, s[56:57] nt
s_add_u32 s56, s56, s48
s_addc_u32 s57, s57, 0
global_load_dwordx4 v[104:107], v22, s[56:57] nt
s_add_u32 s56, s56, s48
s_addc_u32 s57, s57, 0
global_load_dwordx4 v[108:111], v22, s[56:57] nt
s_add_u32 s56, s56, s48
s_addc_u32 s57, s57, 0
global_load_dwordx4 v[112:115], v22, s[56:57] nt
s_add_u32 s56, s56, s48
s_addc_u32 s57, s57, 0
global_load_dwordx4 v[116:119], v22, s[56:57] nt
s_add_u32 s56, s56, s48
s_addc_u32 s57, s57, 0
global_load_dwordx4 v[120:123], v22, s[56:57] nt
s_add_u32 s56, s56, s48
s_addc_u32 s57, s57, 0
global_load_dwordx4 v[124:127], v22, s[56:57] nt
s_barrier
L_ctrl2:
s_lshr_b32 s37, s28, 2
s_and_b32 s38, s30, 31
s_lshl_b32 s54, s37, 7
s_lshl_b32 s55, s38, 2
s_add_u32 s39, s54, s55
s_load_dword s33, s[4:5], s39
v_and_b32 v4, 2, v2
v_cmp_eq_u32 vcc, 0, v4
v_mov_b32 v5, 0x01000c0c
v_mov_b32 v6, 0x0c0c0100
v_cndmask_b32 v5, v5, v6, vcc
v_mov_b32 v6, 0x03020c0c
v_mov_b32 v7, 0x0c0c0302
v_cndmask_b32 v6, v6, v7, vcc
v_and_b32 v4, 12, v2
v_mov_b32 v7, 0x0c0c0c0c
v_cmp_eq_u32 vcc, 0, v4
s_nop 1
v_cndmask_b32 v24, v7, v5, vcc
v_cndmask_b32 v25, v7, v6, vcc
v_cmp_eq_u32 vcc, 4, v4
s_nop 1
v_cndmask_b32 v26, v7, v5, vcc
v_cndmask_b32 v27, v7, v6, vcc
v_cmp_eq_u32 vcc, 8, v4
s_nop 1
v_cndmask_b32 v28, v7, v5, vcc
v_cndmask_b32 v29, v7, v6, vcc
v_cmp_eq_u32 vcc, 12, v4
s_nop 1
v_cndmask_b32 v30, v7, v5, vcc
v_cndmask_b32 v31, v7, v6, vcc
s_waitcnt vmcnt(18)
v_or_b32 v21, 15, v21
v_add_u32 v21, 1, v21
v_lshlrev_b32 v44, 16, v16
v_and_b32 v45, 0xffff0000, v16
v_lshlrev_b32 v46, 16, v17
v_and_b32 v47, 0xffff0000, v17
v_lshlrev_b32 v48, 16, v18
v_and_b32 v49, 0xffff0000, v18
v_lshlrev_b32 v50, 16, v19
v_and_b32 v51, 0xffff0000, v19
v_readfirstlane_b32 s31, v21
s_getreg_b32 s44, hwreg(HW_REG_XCC_ID, 0, 4)
s_lshl_b32 s54, s28, 7
s_add_u32 s54, s54, 32768
s_add_u32 s40, s26, s54
s_addc_u32 s41, s27, 0
s_or_b32 s44, s44, s31
s_mov_b32 s45, s44
s_lshl_b32 s55, s29, 2
v_mov_b32 v52, s55
v_mov_b32 v53, s44
v_add_f32 v4, v44, v45
v_add_f32 v5, v46, v47
v_add_f32 v6, v48, v49
v_add_f32 v7, v50, v51
v_add_f32 v4, v4, v5
v_add_f32 v6, v6, v7
v_add_f32 v4, v4, v6
s_nop 1
v_add_f32_dpp v4, v4, v4 row_ror:8 row_mask:0xf bank_mask:0xf
s_nop 1
v_add_f32_dpp v4, v4, v4 row_ror:4 row_mask:0xf bank_mask:0xf
s_nop 1
v_add_f32_dpp v4, v4, v4 row_ror:2 row_mask:0xf bank_mask:0xf
s_nop 1
v_add_f32_dpp v4, v4, v4 row_ror:1 row_mask:0xf bank_mask:0xf
s_nop 1
v_add_f32_dpp v4, v4, v4 row_bcast:15 row_mask:0xa bank_mask:0xf
s_nop 1
v_add_f32_dpp v4, v4, v4 row_bcast:31 row_mask:0xc bank_mask:0xf
s_nop 0
v_readlane_b32 s54, v4, 63
v_mov_b32 v5, 989855744
s_nop 0
v_mul_f32 v20, s54, v5
v_sub_f32 v44, v44, v20
v_sub_f32 v45, v45, v20
v_sub_f32 v46, v46, v20
v_sub_f32 v47, v47, v20
v_sub_f32 v48, v48, v20
v_sub_f32 v49, v49, v20
v_sub_f32 v50, v50, v20
v_sub_f32 v51, v51, v20
v_mul_f32 v4, v44, v44
v_fmac_f32 v4, v45, v45
v_fmac_f32 v4, v46, v46
v_fmac_f32 v4, v47, v47
v_fmac_f32 v4, v48, v48
v_fmac_f32 v4, v49, v49
v_fmac_f32 v4, v50, v50
v_fmac_f32 v4, v51, v51
s_nop 1
v_add_f32_dpp v4, v4, v4 row_ror:8 row_mask:0xf bank_mask:0xf
s_nop 1
v_add_f32_dpp v4, v4, v4 row_ror:4 row_mask:0xf bank_mask:0xf
s_nop 1
v_add_f32_dpp v4, v4, v4 row_ror:2 row_mask:0xf bank_mask:0xf
s_nop 1
v_add_f32_dpp v4, v4, v4 row_ror:1 row_mask:0xf bank_mask:0xf
s_nop 1
v_add_f32_dpp v4, v4, v4 row_bcast:15 row_mask:0xa bank_mask:0xf
s_nop 1
v_add_f32_dpp v4, v4, v4 row_bcast:31 row_mask:0xc bank_mask:0xf
s_nop 0
v_readlane_b32 s54, v4, 63
v_cvt_pk_bf16_f32 v20, v20, v20
v_and_b32 v20, 0xffff0000, v20
v_mul_f32 v4, s54, v5
v_cvt_pk_bf16_f32 v4, v4, v4
v_and_b32 v4, 0xffff0000, v4
v_add_f32 v4, 925353388, v4
v_cvt_pk_bf16_f32 v4, v4, v4
v_and_b32 v4, 0xffff0000, v4
v_sqrt_f32 v4, v4
s_nop 0
v_cvt_pk_bf16_f32 v4, v4, v4
v_and_b32 v4, 0xffff0000, v4
v_rcp_f32 v6, v4
v_mov_b32 v21, v20
v_mov_b32 v5, v4
v_mov_b32 v7, v6
s_waitcnt vmcnt(16)
v_lshlrev_b32 v44, 16, v8
v_and_b32 v45, 0xffff0000, v8
v_pk_add_f32 v[44:45], v[44:45], v[20:21] neg_lo:[0,1] neg_hi:[0,1]
v_cvt_pk_bf16_f32 v46, v44, v45
v_lshlrev_b32 v44, 16, v46
v_and_b32 v45, 0xffff0000, v46
v_pk_mul_f32 v[46:47], v[44:45], v[6:7]
v_pk_fma_f32 v[44:45], v[46:47], v[4:5], v[44:45] neg_lo:[1,0,0] neg_hi:[1,0,0]
v_pk_fma_f32 v[46:47], v[44:45], v[6:7], v[46:47]
v_cvt_pk_bf16_f32 v8, v46, v47
v_lshlrev_b32 v44, 16, v9
v_and_b32 v45, 0xffff0000, v9
v_pk_add_f32 v[44:45], v[44:45], v[20:21] neg_lo:[0,1] neg_hi:[0,1]
v_cvt_pk_bf16_f32 v46, v44, v45
v_lshlrev_b32 v44, 16, v46
v_and_b32 v45, 0xffff0000, v46
v_pk_mul_f32 v[46:47], v[44:45], v[6:7]
v_pk_fma_f32 v[44:45], v[46:47], v[4:5], v[44:45] neg_lo:[1,0,0] neg_hi:[1,0,0]
v_pk_fma_f32 v[46:47], v[44:45], v[6:7], v[46:47]
v_cvt_pk_bf16_f32 v9, v46, v47
v_lshlrev_b32 v44, 16, v10
v_and_b32 v45, 0xffff0000, v10
v_pk_add_f32 v[44:45], v[44:45], v[20:21] neg_lo:[0,1] neg_hi:[0,1]
v_cvt_pk_bf16_f32 v46, v44, v45
v_lshlrev_b32 v44, 16, v46
v_and_b32 v45, 0xffff0000, v46
v_pk_mul_f32 v[46:47], v[44:45], v[6:7]
v_pk_fma_f32 v[44:45], v[46:47], v[4:5], v[44:45] neg_lo:[1,0,0] neg_hi:[1,0,0]
v_pk_fma_f32 v[46:47], v[44:45], v[6:7], v[46:47]
v_cvt_pk_bf16_f32 v10, v46, v47
v_lshlrev_b32 v44, 16, v11
v_and_b32 v45, 0xffff0000, v11
v_pk_add_f32 v[44:45], v[44:45], v[20:21] neg_lo:[0,1] neg_hi:[0,1]
v_cvt_pk_bf16_f32 v46, v44, v45
v_lshlrev_b32 v44, 16, v46
v_and_b32 v45, 0xffff0000, v46
v_pk_mul_f32 v[46:47], v[44:45], v[6:7]
v_pk_fma_f32 v[44:45], v[46:47], v[4:5], v[44:45] neg_lo:[1,0,0] neg_hi:[1,0,0]
v_pk_fma_f32 v[46:47], v[44:45], v[6:7], v[46:47]
v_cvt_pk_bf16_f32 v11, v46, v47
v_lshlrev_b32 v44, 16, v12
v_and_b32 v45, 0xffff0000, v12
v_pk_add_f32 v[44:45], v[44:45], v[20:21] neg_lo:[0,1] neg_hi:[0,1]
v_cvt_pk_bf16_f32 v46, v44, v45
v_lshlrev_b32 v44, 16, v46
v_and_b32 v45, 0xffff0000, v46
v_pk_mul_f32 v[46:47], v[44:45], v[6:7]
v_pk_fma_f32 v[44:45], v[46:47], v[4:5], v[44:45] neg_lo:[1,0,0] neg_hi:[1,0,0]
v_pk_fma_f32 v[46:47], v[44:45], v[6:7], v[46:47]
v_cvt_pk_bf16_f32 v12, v46, v47
v_lshlrev_b32 v44, 16, v13
v_and_b32 v45, 0xffff0000, v13
v_pk_add_f32 v[44:45], v[44:45], v[20:21] neg_lo:[0,1] neg_hi:[0,1]
v_cvt_pk_bf16_f32 v46, v44, v45
v_lshlrev_b32 v44, 16, v46
v_and_b32 v45, 0xffff0000, v46
v_pk_mul_f32 v[46:47], v[44:45], v[6:7]
v_pk_fma_f32 v[44:45], v[46:47], v[4:5], v[44:45] neg_lo:[1,0,0] neg_hi:[1,0,0]
v_pk_fma_f32 v[46:47], v[44:45], v[6:7], v[46:47]
v_cvt_pk_bf16_f32 v13, v46, v47
v_lshlrev_b32 v44, 16, v14
v_and_b32 v45, 0xffff0000, v14
v_pk_add_f32 v[44:45], v[44:45], v[20:21] neg_lo:[0,1] neg_hi:[0,1]
v_cvt_pk_bf16_f32 v46, v44, v45
v_lshlrev_b32 v44, 16, v46
v_and_b32 v45, 0xffff0000, v46
v_pk_mul_f32 v[46:47], v[44:45], v[6:7]
v_pk_fma_f32 v[44:45], v[46:47], v[4:5], v[44:45] neg_lo:[1,0,0] neg_hi:[1,0,0]
v_pk_fma_f32 v[46:47], v[44:45], v[6:7], v[46:47]
v_cvt_pk_bf16_f32 v14, v46, v47
v_lshlrev_b32 v44, 16, v15
v_and_b32 v45, 0xffff0000, v15
v_pk_add_f32 v[44:45], v[44:45], v[20:21] neg_lo:[0,1] neg_hi:[0,1]
v_cvt_pk_bf16_f32 v46, v44, v45
v_lshlrev_b32 v44, 16, v46
v_and_b32 v45, 0xffff0000, v46
v_pk_mul_f32 v[46:47], v[44:45], v[6:7]
v_pk_fma_f32 v[44:45], v[46:47], v[4:5], v[44:45] neg_lo:[1,0,0] neg_hi:[1,0,0]
v_pk_fma_f32 v[46:47], v[44:45], v[6:7], v[46:47]
v_cvt_pk_bf16_f32 v15, v46, v47
v_perm_b32 v32, v8, v8, v24
v_perm_b32 v33, v8, v8, v26
v_perm_b32 v34, v8, v8, v28
v_perm_b32 v35, v8, v8, v30
v_perm_b32 v36, v8, v8, v25
v_perm_b32 v37, v8, v8, v27
v_perm_b32 v38, v8, v8, v29
v_perm_b32 v39, v8, v8, v31
s_waitcnt vmcnt(15)
v_mfma_f32_16x16x32_bf16 v[40:43], v[32:35], v[64:67], 0
v_perm_b32 v32, v9, v9, v24
v_perm_b32 v33, v9, v9, v26
v_perm_b32 v34, v9, v9, v28
v_perm_b32 v35, v9, v9, v30
s_waitcnt vmcnt(14)
v_mfma_f32_16x16x32_bf16 v[40:43], v[36:39], v[68:71], v[40:43]
v_perm_b32 v36, v9, v9, v25
v_perm_b32 v37, v9, v9, v27
v_perm_b32 v38, v9, v9, v29
v_perm_b32 v39, v9, v9, v31
s_waitcnt vmcnt(13)
v_mfma_f32_16x16x32_bf16 v[40:43], v[32:35], v[72:75], v[40:43]
v_perm_b32 v32, v10, v10, v24
v_perm_b32 v33, v10, v10, v26
v_perm_b32 v34, v10, v10, v28
v_perm_b32 v35, v10, v10, v30
s_waitcnt vmcnt(12)
v_mfma_f32_16x16x32_bf16 v[40:43], v[36:39], v[76:79], v[40:43]
v_perm_b32 v36, v10, v10, v25
v_perm_b32 v37, v10, v10, v27
v_perm_b32 v38, v10, v10, v29
v_perm_b32 v39, v10, v10, v31
s_waitcnt vmcnt(11)
v_mfma_f32_16x16x32_bf16 v[40:43], v[32:35], v[80:83], v[40:43]
v_perm_b32 v32, v11, v11, v24
v_perm_b32 v33, v11, v11, v26
v_perm_b32 v34, v11, v11, v28
v_perm_b32 v35, v11, v11, v30
s_waitcnt vmcnt(10)
v_mfma_f32_16x16x32_bf16 v[40:43], v[36:39], v[84:87], v[40:43]
v_perm_b32 v36, v11, v11, v25
v_perm_b32 v37, v11, v11, v27
v_perm_b32 v38, v11, v11, v29
v_perm_b32 v39, v11, v11, v31
s_waitcnt vmcnt(9)
v_mfma_f32_16x16x32_bf16 v[40:43], v[32:35], v[88:91], v[40:43]
v_perm_b32 v32, v12, v12, v24
v_perm_b32 v33, v12, v12, v26
v_perm_b32 v34, v12, v12, v28
v_perm_b32 v35, v12, v12, v30
s_waitcnt vmcnt(8)
v_mfma_f32_16x16x32_bf16 v[40:43], v[36:39], v[92:95], v[40:43]
v_perm_b32 v36, v12, v12, v25
v_perm_b32 v37, v12, v12, v27
v_perm_b32 v38, v12, v12, v29
v_perm_b32 v39, v12, v12, v31
s_waitcnt vmcnt(7)
v_mfma_f32_16x16x32_bf16 v[40:43], v[32:35], v[96:99], v[40:43]
v_perm_b32 v32, v13, v13, v24
v_perm_b32 v33, v13, v13, v26
v_perm_b32 v34, v13, v13, v28
v_perm_b32 v35, v13, v13, v30
s_waitcnt vmcnt(6)
v_mfma_f32_16x16x32_bf16 v[40:43], v[36:39], v[100:103], v[40:43]
v_perm_b32 v36, v13, v13, v25
v_perm_b32 v37, v13, v13, v27
v_perm_b32 v38, v13, v13, v29
v_perm_b32 v39, v13, v13, v31
s_waitcnt vmcnt(5)
v_mfma_f32_16x16x32_bf16 v[40:43], v[32:35], v[104:107], v[40:43]
v_perm_b32 v32, v14, v14, v24
v_perm_b32 v33, v14, v14, v26
v_perm_b32 v34, v14, v14, v28
v_perm_b32 v35, v14, v14, v30
s_waitcnt vmcnt(4)
v_mfma_f32_16x16x32_bf16 v[40:43], v[36:39], v[108:111], v[40:43]
v_perm_b32 v36, v14, v14, v25
v_perm_b32 v37, v14, v14, v27
v_perm_b32 v38, v14, v14, v29
v_perm_b32 v39, v14, v14, v31
s_waitcnt vmcnt(3)
v_mfma_f32_16x16x32_bf16 v[40:43], v[32:35], v[112:115], v[40:43]
v_perm_b32 v32, v15, v15, v24
v_perm_b32 v33, v15, v15, v26
v_perm_b32 v34, v15, v15, v28
v_perm_b32 v35, v15, v15, v30
s_waitcnt vmcnt(2)
v_mfma_f32_16x16x32_bf16 v[40:43], v[36:39], v[116:119], v[40:43]
v_perm_b32 v36, v15, v15, v25
v_perm_b32 v37, v15, v15, v27
v_perm_b32 v38, v15, v15, v29
v_perm_b32 v39, v15, v15, v31
s_waitcnt vmcnt(1)
v_mfma_f32_16x16x32_bf16 v[40:43], v[32:35], v[120:123], v[40:43]
s_nop 1
s_waitcnt vmcnt(0)
v_mfma_f32_16x16x32_bf16 v[40:43], v[36:39], v[124:127], v[40:43]
s_mul_i32 s54, s3, 262144
s_add_u32 s54, s54, 65536
s_lshl_b32 s55, s30, 10
s_add_u32 s55, s55, s54
v_and_b32 v6, 7, v2
v_lshl_add_u32 v6, v3, 3, v6
v_lshl_add_u32 v4, v6, 4, s55
s_lshl_b32 s55, s28, 13
s_add_u32 s55, s55, s54
s_add_u32 s55, s55, 4096
v_lshl_add_u32 v5, v6, 4, s55
v_lshrrev_b32 v6, 3, v2
v_lshl_add_u32 v5, v6, 10, v5
v_add_f32_dpp v40, v41, v40 row_ror:8 row_mask:0xf bank_mask:0xf
v_add_f32_dpp v42, v43, v42 row_ror:8 row_mask:0xf bank_mask:0xf
s_lshl_b32 s54, s28, 8
s_lshl_b32 s55, s3, 7
s_add_u32 s54, s54, s55
s_add_u32 s54, s54, 16384
v_mov_b32 v41, s31
v_mov_b32 v43, s31
s_add_u32 s46, s26, s54
s_addc_u32 s47, s27, 0
s_mov_b32 exec_lo, 0x00ff00ff
s_mov_b32 exec_hi, 0x00ff00ff
global_store_dwordx4 v4, v[40:43], s[26:27] sc1
L_q_stored:
s_mov_b64 exec, 1
global_store_dword v52, v53, s[46:47] sc1
s_mov_b64 exec, -1
s_mov_b32 s32, 0
s_mov_b32 s43, 1
L_qhint:
s_load_dwordx8 s[56:63], s[46:47], 0 glc
s_add_u32 s32, s32, 1
s_cmp_ge_u32 s32, 1048576
s_cbranch_scc1 L_qpoll
s_waitcnt lgkmcnt(0)
s_xor_b64 s[56:57], s[56:57], s[44:45]
s_xor_b64 s[58:59], s[58:59], s[44:45]
s_xor_b64 s[60:61], s[60:61], s[44:45]
s_xor_b64 s[62:63], s[62:63], s[44:45]
s_or_b64 s[56:57], s[56:57], s[58:59]
s_or_b64 s[60:61], s[60:61], s[62:63]
s_or_b64 s[56:57], s[56:57], s[60:61]
s_or_b32 s43, s56, s57
s_cmp_lt_u32 s43, 16
s_cbranch_scc1 L_qpoll
s_sleep 4
s_branch L_qhint
L_qpoll:
global_load_dwordx4 v[64:67], v5, s[26:27] offset:-4096 sc1
global_load_dwordx4 v[68:71], v5, s[26:27] offset:-2048 sc1
global_load_dwordx4 v[72:75], v5, s[26:27] offset:0 sc1
global_load_dwordx4 v[76:79], v5, s[26:27] offset:2048 sc1
s_add_u32 s32, s32, 1
s_waitcnt vmcnt(3)
v_xor_b32 v6, s31, v65
v_mov_b32 v44, v64
v_mov_b32 v45, v66
v_bitop3_b32 v6, v67, s31, v6 bitop3:0xbe
s_waitcnt vmcnt(2)
v_bitop3_b32 v6, v69, s31, v6 bitop3:0xbe
v_add_f32 v44, v44, v68
v_add_f32 v45, v45, v70
v_bitop3_b32 v6, v71, s31, v6 bitop3:0xbe
s_waitcnt vmcnt(1)
v_bitop3_b32 v6, v73, s31, v6 bitop3:0xbe
v_add_f32 v44, v44, v72
v_add_f32 v45, v45, v74
v_bitop3_b32 v6, v75, s31, v6 bitop3:0xbe
s_waitcnt vmcnt(0)
v_bitop3_b32 v6, v77, s31, v6 bitop3:0xbe
v_add_f32 v44, v44, v76
v_add_f32 v45, v45, v78
v_bitop3_b32 v6, v79, s31, v6 bitop3:0xbe
v_cmp_ne_u32 vcc, 0, v6
s_cbranch_vccz L_qdone
s_cmp_lt_u32 s32, 1048576
s_cbranch_scc1 L_qhint
L_qdone:
v_cvt_pk_bf16_f32 v44, v44, v45
v_lshlrev_b32 v22, 4, v2
v_lshl_add_u32 v22, v3, 2, v22
s_cmp_eq_u32 s3, 0
s_cbranch_scc1 L_c0
v_mov_b32_dpp v45, v44 row_ror:8 row_mask:0xf bank_mask:0xf
v_lshlrev_b32 v46, 16, v44
v_and_b32 v47, 0xffff0000, v44
v_mov_b32 v50, 1027024659
v_mul_f32 v48, v46, v46
v_mul_f32 v49, v47, v47
v_mul_f32 v48, v48, v46
v_mul_f32 v49, v49, v47
v_fma_f32 v48, v48, v50, v46
v_fma_f32 v49, v49, v50, v47
v_mul_f32 v48, 3222493025, v48
v_mul_f32 v49, 3222493025, v49
v_exp_f32 v48, v48
v_exp_f32 v49, v49
s_nop 0
v_add_f32 v48, 1.0, v48
v_add_f32 v49, 1.0, v49
v_rcp_f32 v48, v48
v_rcp_f32 v49, v49
s_nop 0
v_mul_f32 v46, v46, v48
v_mul_f32 v47, v47, v49
v_cvt_pk_bf16_f32 v44, v46, v47
v_lshlrev_b32 v46, 16, v44
v_and_b32 v47, 0xffff0000, v44
v_lshlrev_b32 v48, 16, v45
v_and_b32 v49, 0xffff0000, v45
v_cmp_gt_u32 vcc, s53, v2
v_mul_f32 v46, v46, v48
v_mul_f32 v47, v47, v49
v_cvt_pk_bf16_f32 v44, v46, v47
v_cndmask_b32 v44, 0, v44, vcc
ds_write_b32 v22, v44 offset:256
s_waitcnt lgkmcnt(0)
s_endpgm
L_c0:
v_mov_b32 v21, 768
v_mov_b32 v6, 1
v_mov_b32 v7, s31
ds_write_b32 v22, v44 offset:0
ds_write_b64 v21, v[6:7]
v_and_b32 v4, 3, v0
v_lshlrev_b32 v4, 3, v4
s_lshl_b32 s54, s28, 7
s_add_u32 s54, s54, 589824
s_add_u32 s46, s26, s54
s_addc_u32 s47, s27, 0
s_lshl_b32 s54, s29, 4
v_mov_b32 v24, s54
s_lshl_b32 s54, s30, 10
s_add_u32 s54, s54, 65536
v_lshl_add_u32 v26, v0, 4, s54
s_lshl_b32 s54, s28, 13
s_add_u32 s54, s54, 69632
v_lshl_add_u32 v27, v0, 4, s54
s_lshl_b32 s54, s37, 16
s_lshl_b32 s55, s38, 5
s_add_u32 s54, s54, s55
s_lshr_b32 s55, s37, 2
s_xor_b32 s55, s55, 0
s_lshl_b32 s55, s55, 13
s_add_u32 s54, s54, 1048576
v_bfe_u32 v5, v0, 1, 3
v_lshlrev_b32 v5, 10, v5
v_lshl_add_u32 v5, v3, 13, v5
v_and_b32 v6, 1, v0
v_lshl_add_u32 v5, v6, 4, v5
v_add_u32 v28, s54, v5
v_lshl_add_u32 v29, v0, 1, s39
v_lshlrev_b32 v30, 3, v0
v_mov_b32 v31, 1069066811
v_cmp_eq_u32 vcc, 0, v6
s_lshl_b32 s54, s33, 16
s_and_b32 s55, s33, 0xffff0000
v_mov_b32 v20, s55
v_mov_b32 v23, s54
v_cndmask_b32 v20, v20, v23, vcc
v_mov_b32 v13, s31
v_mov_b32 v15, s31
v_mov_b32 v32, s31
v_mov_b32 v33, s31
s_add_u32 s42, s31, 1
v_mov_b32 v41, s42
v_mov_b32 v43, s42
s_mov_b32 s32, 0
L_wait_c:
ds_read_b32 v7, v21 offset:12
s_add_u32 s32, s32, 1
s_waitcnt lgkmcnt(0)
v_readfirstlane_b32 s48, v7
s_cmp_ge_u32 s48, 4
s_cbranch_scc1 L_go_c
s_sleep 2
s_cmp_lt_u32 s32, 1048576
s_cbranch_scc1 L_wait_c
L_go_c:
ds_read_b64 v[8:9], v4 offset:832
s_waitcnt lgkmcnt(0)
v_mov_b32 v12, v8
s_nop 1
v_max_f32_dpp v12, v12, v12 quad_perm:[1,0,3,2] row_mask:0xf bank_mask:0xf
s_nop 1
v_max_f32_dpp v12, v12, v12 quad_perm:[2,3,0,1] row_mask:0xf bank_mask:0xf
v_sub_f32 v8, v8, v12
v_mul_f32 v8, v8, v31
v_exp_f32 v8, v8
s_nop 0
v_mul_f32 v14, v8, v9
s_nop 1
v_add_f32_dpp v14, v14, v14 quad_perm:[1,0,3,2] row_mask:0xf bank_mask:0xf
s_nop 1
v_add_f32_dpp v14, v14, v14 quad_perm:[2,3,0,1] row_mask:0xf bank_mask:0xf
s_mov_b64 exec, 1
global_store_dwordx4 v24, v[12:15], s[46:47] sc1
s_mov_b64 exec, -1
s_mov_b32 s32, 0
L_mlpoll:
s_load_dwordx16 s[48:63], s[46:47], 0 glc
s_load_dwordx16 s[64:79], s[46:47], 64 glc
s_add_u32 s32, s32, 1
s_waitcnt lgkmcnt(0)
s_xor_b32 s80, s49, s31
s_xor_b32 s81, s51, s31
s_or_b32 s80, s80, s81
s_xor_b32 s81, s53, s31
s_or_b32 s80, s80, s81
s_xor_b32 s81, s55, s31
s_or_b32 s80, s80, s81
s_xor_b32 s81, s57, s31
s_or_b32 s80, s80, s81
s_xor_b32 s81, s59, s31
s_or_b32 s80, s80, s81
s_xor_b32 s81, s61, s31
s_or_b32 s80, s80, s81
s_xor_b32 s81, s63, s31
s_or_b32 s80, s80, s81
s_xor_b32 s81, s65, s31
s_or_b32 s80, s80, s81
s_xor_b32 s81, s67, s31
s_or_b32 s80, s80, s81
s_xor_b32 s81, s69, s31
s_or_b32 s80, s80, s81
s_xor_b32 s81, s71, s31
s_or_b32 s80, s80, s81
s_xor_b32 s81, s73, s31
s_or_b32 s80, s80, s81
s_xor_b32 s81, s75, s31
s_or_b32 s80, s80, s81
s_xor_b32 s81, s77, s31
s_or_b32 s80, s80, s81
s_xor_b32 s81, s79, s31
s_or_b32 s80, s80, s81
s_cmp_eq_u32 s80, 0
s_cbranch_scc1 L_mldone
s_sleep 4
s_cmp_lt_u32 s32, 1048576
s_cbranch_scc1 L_mlpoll
L_mldone:
v_mov_b32 v8, s48
v_max_f32 v8, s52, v8
v_max_f32 v8, s56, v8
v_max_f32 v8, s60, v8
v_max_f32 v8, s64, v8
v_max_f32 v8, s68, v8
v_max_f32 v8, s72, v8
v_max_f32 v8, s76, v8
v_sub_f32 v64, s48, v8
v_sub_f32 v65, s52, v8
v_sub_f32 v66, s56, v8
v_sub_f32 v67, s60, v8
v_sub_f32 v68, s64, v8
v_sub_f32 v69, s68, v8
v_sub_f32 v70, s72, v8
v_sub_f32 v71, s76, v8
v_mul_f32 v64, v64, v31
v_mul_f32 v65, v65, v31
v_mul_f32 v66, v66, v31
v_mul_f32 v67, v67, v31
v_mul_f32 v68, v68, v31
v_mul_f32 v69, v69, v31
v_mul_f32 v70, v70, v31
v_mul_f32 v71, v71, v31
v_exp_f32 v64, v64
v_exp_f32 v65, v65
v_exp_f32 v66, v66
v_exp_f32 v67, v67
v_exp_f32 v68, v68
v_exp_f32 v69, v69
v_exp_f32 v70, v70
v_exp_f32 v71, v71
v_mul_f32 v9, s50, v64
v_fmac_f32 v9, s54, v65
v_fmac_f32 v9, s58, v66
v_fmac_f32 v9, s62, v67
v_fmac_f32 v9, s66, v68
v_fmac_f32 v9, s70, v69
v_fmac_f32 v9, s74, v70
v_fmac_f32 v9, s78, v71
v_rcp_f32 v9, v9
s_mov_b32 s32, 0
v_mov_b32 v10, 1
ds_write_b64 v21, v[8:9] offset:32
ds_write_b32 v21, v10 offset:24
s_waitcnt vmcnt(0) lgkmcnt(0)
s_barrier
ds_read2st64_b64 v[64:67], v30 offset0:2 offset1:3
ds_read2st64_b64 v[68:71], v30 offset0:4 offset1:5
s_cmp_eq_u32 s43, 0
s_waitcnt lgkmcnt(1)
v_pk_add_f32 v[64:65], v[64:65], v[66:67]
s_waitcnt lgkmcnt(0)
v_pk_add_f32 v[68:69], v[68:69], v[70:71]
v_add_f32 v40, v64, v68
v_add_f32 v42, v65, v69
s_cbranch_scc0 L_o_remote
global_store_dwordx4 v26, v[40:43], s[26:27]
L_opoll:
global_load_dwordx4 v[64:67], v27, s[26:27] offset:-4096 sc1
global_load_dwordx4 v[68:71], v27, s[26:27] offset:-3072 sc1
global_load_dwordx4 v[72:75], v27, s[26:27] offset:-2048 sc1
global_load_dwordx4 v[76:79], v27, s[26:27] offset:-1024 sc1
global_load_dwordx4 v[80:83], v27, s[26:27] offset:0 sc1
global_load_dwordx4 v[84:87], v27, s[26:27] offset:1024 sc1
global_load_dwordx4 v[88:91], v27, s[26:27] offset:2048 sc1
global_load_dwordx4 v[92:95], v27, s[26:27] offset:3072 sc1
s_waitcnt vmcnt(7)
v_xor_b32 v48, s42, v65
v_bitop3_b32 v48, v67, s42, v48 bitop3:0xbe
s_waitcnt vmcnt(6)
v_xor_b32 v49, s42, v69
v_bitop3_b32 v49, v71, s42, v49 bitop3:0xbe
s_waitcnt vmcnt(5)
v_xor_b32 v50, s42, v73
v_bitop3_b32 v50, v75, s42, v50 bitop3:0xbe
s_waitcnt vmcnt(4)
v_xor_b32 v51, s42, v77
v_bitop3_b32 v51, v79, s42, v51 bitop3:0xbe
s_waitcnt vmcnt(3)
v_xor_b32 v52, s42, v81
v_bitop3_b32 v52, v83, s42, v52 bitop3:0xbe
s_waitcnt vmcnt(2)
v_xor_b32 v53, s42, v85
v_bitop3_b32 v53, v87, s42, v53 bitop3:0xbe
s_waitcnt vmcnt(1)
v_xor_b32 v54, s42, v89
v_bitop3_b32 v54, v91, s42, v54 bitop3:0xbe
s_waitcnt vmcnt(0)
v_xor_b32 v55, s42, v93
v_bitop3_b32 v55, v95, s42, v55 bitop3:0xbe
v_or3_b32 v6, v48, v49, v50
v_or3_b32 v7, v51, v52, v53
v_or3_b32 v6, v6, v54, v55
v_or_b32 v6, v6, v7
v_cmp_ne_u32 vcc, 0, v6
s_cbranch_vccz L_osum
v_cmp_ne_u32 s[64:65], 0, v48
v_cmp_ne_u32 s[66:67], 0, v49
v_cmp_ne_u32 s[68:69], 0, v50
v_cmp_ne_u32 s[70:71], 0, v51
v_cmp_ne_u32 s[72:73], 0, v52
v_cmp_ne_u32 s[74:75], 0, v53
v_cmp_ne_u32 s[76:77], 0, v54
v_cmp_ne_u32 s[78:79], 0, v55
s_mov_b64 exec, s[64:65]
global_load_dwordx4 v[64:67], v27, s[26:27] offset:-4096 sc1
s_mov_b64 exec, s[66:67]
global_load_dwordx4 v[68:71], v27, s[26:27] offset:-3072 sc1
s_mov_b64 exec, s[68:69]
global_load_dwordx4 v[72:75], v27, s[26:27] offset:-2048 sc1
s_mov_b64 exec, s[70:71]
global_load_dwordx4 v[76:79], v27, s[26:27] offset:-1024 sc1
s_mov_b64 exec, s[72:73]
global_load_dwordx4 v[80:83], v27, s[26:27] offset:0 sc1
s_mov_b64 exec, s[74:75]
global_load_dwordx4 v[84:87], v27, s[26:27] offset:1024 sc1
s_mov_b64 exec, s[76:77]
global_load_dwordx4 v[88:91], v27, s[26:27] offset:2048 sc1
s_mov_b64 exec, s[78:79]
global_load_dwordx4 v[92:95], v27, s[26:27] offset:3072 sc1
s_mov_b64 exec, -1
L_oround:
s_add_u32 s32, s32, 1
s_cmp_lt_u32 s32, 1048576
s_cbranch_scc0 L_osum
v_cmp_ne_u32 s[64:65], 0, v48
v_cmp_ne_u32 s[66:67], 0, v49
v_cmp_ne_u32 s[68:69], 0, v50
v_cmp_ne_u32 s[70:71], 0, v51
v_cmp_ne_u32 s[72:73], 0, v52
v_cmp_ne_u32 s[74:75], 0, v53
v_cmp_ne_u32 s[76:77], 0, v54
v_cmp_ne_u32 s[78:79], 0, v55
s_mov_b64 exec, s[64:65]
global_load_dwordx4 v[64:67], v27, s[26:27] offset:-4096 sc1
s_mov_b64 exec, s[66:67]
global_load_dwordx4 v[68:71], v27, s[26:27] offset:-3072 sc1
s_mov_b64 exec, s[68:69]
global_load_dwordx4 v[72:75], v27, s[26:27] offset:-2048 sc1
s_mov_b64 exec, s[70:71]
global_load_dwordx4 v[76:79], v27, s[26:27] offset:-1024 sc1
s_mov_b64 exec, s[72:73]
global_load_dwordx4 v[80:83], v27, s[26:27] offset:0 sc1
s_mov_b64 exec, s[74:75]
global_load_dwordx4 v[84:87], v27, s[26:27] offset:1024 sc1
s_mov_b64 exec, s[76:77]
global_load_dwordx4 v[88:91], v27, s[26:27] offset:2048 sc1
s_mov_b64 exec, s[78:79]
global_load_dwordx4 v[92:95], v27, s[26:27] offset:3072 sc1
s_mov_b64 exec, -1
s_waitcnt vmcnt(8)
v_xor_b32 v48, s42, v65
v_bitop3_b32 v48, v67, s42, v48 bitop3:0xbe
v_xor_b32 v49, s42, v69
v_bitop3_b32 v49, v71, s42, v49 bitop3:0xbe
v_xor_b32 v50, s42, v73
v_bitop3_b32 v50, v75, s42, v50 bitop3:0xbe
v_xor_b32 v51, s42, v77
v_bitop3_b32 v51, v79, s42, v51 bitop3:0xbe
v_xor_b32 v52, s42, v81
v_bitop3_b32 v52, v83, s42, v52 bitop3:0xbe
v_xor_b32 v53, s42, v85
v_bitop3_b32 v53, v87, s42, v53 bitop3:0xbe
v_xor_b32 v54, s42, v89
v_bitop3_b32 v54, v91, s42, v54 bitop3:0xbe
v_xor_b32 v55, s42, v93
v_bitop3_b32 v55, v95, s42, v55 bitop3:0xbe
v_or3_b32 v6, v48, v49, v50
v_or3_b32 v7, v51, v52, v53
v_or3_b32 v6, v6, v54, v55
v_or_b32 v6, v6, v7
v_cmp_ne_u32 vcc, 0, v6
s_cbranch_vccnz L_oround
L_osum:
s_waitcnt vmcnt(0)
v_add_f32 v44, v64, v68
v_add_f32 v45, v66, v70
v_add_f32 v46, v72, v76
v_add_f32 v47, v74, v78
v_add_f32 v56, v80, v84
v_add_f32 v57, v82, v86
v_add_f32 v58, v88, v92
v_add_f32 v59, v90, v94
v_pk_add_f32 v[44:45], v[44:45], v[46:47]
v_pk_add_f32 v[56:57], v[56:57], v[58:59]
v_pk_add_f32 v[44:45], v[44:45], v[56:57]
v_cvt_pk_bf16_f32 v44, v44, v45
L_odone:
ds_write_b32 v22, v44 offset:512
s_mov_b32 s32, 0
s_waitcnt lgkmcnt(0)
s_barrier
s_mov_b64 vcc, -1
global_load_dwordx4 v[8:11], v28, s[26:27] sc1
s_branch L_yload
L_ypoll:
s_bcnt1_i32_b64 s48, vcc
s_cmp_gt_u32 s48, 16
s_cbranch_scc1 L_ysleep
L_yload:
s_add_u32 s32, s32, 1
s_cmp_ge_u32 s32, 1048576
s_cbranch_scc1 L_ydone
s_mov_b64 exec, vcc
global_load_dwordx4 v[8:11], v28, s[26:27] sc1
s_mov_b64 exec, -1
s_waitcnt vmcnt(1)
v_xor_b32 v6, s31, v9
v_bitop3_b32 v6, v11, s31, v6 bitop3:0xbe
v_cmp_ne_u32 vcc, 0, v6
s_cbranch_vccnz L_ypoll
L_ydone:
s_waitcnt vmcnt(0)
v_permlane32_swap_b32 v8, v10
v_add_f32 v16, v8, v10
v_add_f32 v18, v8, v10
s_nop 1
v_permlane16_swap_b32 v16, v18
v_add_f32 v16, v16, v18
s_nop 1
v_add_f32_dpp v16, v16, v16 quad_perm:[2,3,0,1] row_mask:0xf bank_mask:0xf
s_nop 1
v_add_f32_dpp v16, v16, v16 row_ror:4 row_mask:0xf bank_mask:0xf
s_nop 1
v_add_f32_dpp v16, v16, v16 row_ror:8 row_mask:0xf bank_mask:0xf
v_cvt_pk_bf16_f32 v16, v16, v16
v_and_b32 v16, 0xffff0000, v16
v_add_f32 v12, v20, v16
v_mov_b32 v18, v16
v_cvt_pk_bf16_f32 v12, v12, v12
v_and_b32 v12, 0xffff0000, v12
v_permlane32_swap_b32 v16, v18
v_add_f32 v12, v12, v18
v_cvt_pk_bf16_f32 v12, v12, v12
s_mov_b64 exec, 3
global_store_short v29, v12, s[22:23]
s_cmp_lg_u32 s30, 0
s_cbranch_scc1 L_c0_end
s_mov_b64 exec, 0xffff
global_store_dwordx2 v30, v[32:33], s[26:27]
L_c0_end:
s_endpgm
L_ysleep:
s_sleep 4
s_branch L_yload
L_o_remote:
global_store_dwordx4 v26, v[40:43], s[26:27] sc1
s_branch L_opoll
L_end:
s_endpgm
L_last:
.section .rodata,"a"
.p2align 6
.amdhsa_kernel parallel_sum__gqa_block_cached__geglu_ffn__decode_kernel
.amdhsa_next_free_vgpr 160
.amdhsa_next_free_sgpr 102
.amdhsa_accum_offset 160
.amdhsa_group_segment_fixed_size 0
.amdhsa_kernarg_size 96
.amdhsa_user_sgpr_count 2
.amdhsa_user_sgpr_kernarg_segment_ptr 1
.amdhsa_system_sgpr_workgroup_id_x 1
.end_amdhsa_kernel
```
